```python
import torch

def _softmax(x, axis=-1):
    return torch.softmax(x, dim=axis)

def _gelu(x):
    return torch.nn.functional.gelu(x, approximate='tanh')

def _silu(x):
    return torch.nn.functional.silu(x)

def _sigmoid(x):
    return torch.sigmoid(x)

def _layernorm(x, axis=-1, eps=1e-05):
    m = x.mean(dim=axis, keepdim=True)
    v = x.var(dim=axis, keepdim=True, unbiased=False)
    return (x - m) / torch.sqrt(v + eps)

def _scatter_add(tgt, idx, src, axis=0):
    return tgt.clone().index_add_(axis, idx, src)

def _segment_sum(src, seg, n):
    out = torch.zeros((n,) + src.shape[1:], dtype=src.dtype)
    return out.index_add_(0, seg, src)

def _pad(x, pw):
    flat = tuple((v for pair in reversed(pw) for v in pair))
    return torch.nn.functional.pad(x, flat)
kernel_name = 'adaLN_cond__spectral_gfnet__glu_gated_geglu__prompt'

def setup_inputs():

    _w = lambda a: (lambda t: t.to(torch.bfloat16) if t.is_floating_point() else t)(torch.as_tensor(a))

    def _A_setup():
        B, S, D = (1, 2048, 640)
        Df = D // 2 + 1
        return {'x': _w((lambda *s: torch.randn(*s, dtype=torch.bfloat16) * 0.05)(B, S, D)), 'w_r': _w((lambda *s: torch.randn(*s, dtype=torch.bfloat16) * 3.2)(S, Df) * 0.02), 'w_i': _w((lambda *s: torch.randn(*s, dtype=torch.bfloat16) * 3.2)(S, Df) * 0.02)}
    _A_in = _A_setup()

    def _B_setup():
        B, S, Dm, Df = (1, 2048, 640, 1536)
        return {'x': _w((lambda *s: torch.randn(*s, dtype=torch.bfloat16) * 0.05)(B, S, Dm)), 'w_gate': _w((lambda *s: torch.randn(*s, dtype=torch.bfloat16) * 0.4)(Dm, Df) * Dm ** (-0.5)), 'w_up': _w((lambda *s: torch.randn(*s, dtype=torch.bfloat16) * 0.4)(Dm, Df) * Dm ** (-0.5)), 'w_down': _w((lambda *s: torch.randn(*s, dtype=torch.bfloat16) * 0.4)(Df, Dm) * Df ** (-0.5))}
    _B_in = _B_setup()
    return {'A_x': _A_in['x'], 'A_w_r': _A_in['w_r'], 'A_w_i': _A_in['w_i'], 'B_x': _B_in['x'], 'B_w_gate': _B_in['w_gate'], 'B_w_up': _B_in['w_up'], 'B_w_down': _B_in['w_down'], 'c': _w((lambda *s: torch.randn(*s, dtype=torch.bfloat16) * 0.1)(1, 640) * 8.0), 'w_mod': _w((lambda *s: torch.randn(*s, dtype=torch.bfloat16) * 0.1)(640, 6 * 640) * 640 ** (-0.5) * 8.0)}

def reference(A_x, A_w_r, A_w_i, B_x, B_w_gate, B_w_up, B_w_down, c, w_mod):

    def _A_ref(x, w_r, w_i):
        B, S, D = x.shape
        X = (lambda x, axes=(-2, -1): torch.fft.rfft2(x.float(), dim=axes))(x, axes=(-2, -1))
        W = w_r + 1j * w_i
        X = X * W
        y = (lambda x, s, axes=(-2, -1): torch.fft.irfft2(x, s=s, dim=axes).to(torch.bfloat16))(X, (S, D), axes=(-2, -1))
        return y

    def _B_ref(x, w_gate, w_up, w_down):
        g = torch.einsum('bsd,df->bsf', x, w_gate)
        u = torch.einsum('bsd,df->bsf', x, w_up)
        h = _gelu(g) * u
        return torch.einsum('bsf,fd->bsd', h, w_down)
    x = A_x
    mod = (_silu(c) @ w_mod).reshape(c.shape[0], 6, 1, -1)
    sa, ca, ga, sb, cb, gb = (mod[:, 0].clone(), mod[:, 1].clone(), mod[:, 2].clone(), mod[:, 3].clone(), mod[:, 4].clone(), mod[:, 5].clone())
    h = _layernorm(x, axis=-1) * (1 + ca) + sa
    x = x + ga * _A_ref(h, A_w_r, A_w_i)
    h = _layernorm(x, axis=-1) * (1 + cb) + sb
    x = x + gb * _B_ref(h, B_w_gate, B_w_up, B_w_down)
    return x
```

```asm
; @launch grid=(256,1,1) block=(768,1,1) lds=163840
.amdgcn_target "amdgcn-amd-amdhsa--gfx950"
.text
.globl adaLN_cond__spectral_gfnet__glu_gated_geglu__prompt_kernel
.p2align 8
.type adaLN_cond__spectral_gfnet__glu_gated_geglu__prompt_kernel,@function
adaLN_cond__spectral_gfnet__glu_gated_geglu__prompt_kernel:
  s_cmp_ge_u32 s2, 256
  s_cbranch_scc1 KM_end
  s_load_dwordx2 s[4:5], s[0:1], 0
  s_load_dwordx2 s[6:7], s[0:1], 88
  s_load_dwordx4 s[56:59], s[0:1], 56
  s_load_dwordx4 s[24:27], s[0:1], 8
  s_load_dwordx2 s[60:61], s[0:1], 80
  s_and_b32 s50, s2, 7
  s_lshr_b32 s51, s2, 3
  s_mul_i32 s52, s50, 10
  s_add_u32 s52, s52, s51
  s_mul_i32 s21, s50, 20
  s_add_u32 s21, s21, s51
  s_add_u32 s21, s21, 70
  s_cmp_lt_u32 s2, 80
  s_cselect_b32 s52, s52, s21
  s_lshl_b32 s50, s50, 1
  s_lshr_b32 s21, s51, 4
  s_add_u32 s50, s50, s21
  s_and_b32 s51, s51, 15
  v_lshrrev_b32 v4, 6, v0
  v_and_b32 v1, 63, v0
  v_readfirstlane_b32 s22, v4
  s_lshl_b32 s3, s50, 1
  s_lshr_b32 s21, s51, 3
  s_add_u32 s3, s3, s21
  s_and_b32 s20, s51, 7
  s_cmp_ge_u32 s22, 8
  s_cbranch_scc1 KM_prod
  v_and_b32 v3, 31, v0
  v_lshlrev_b32 v2, 3, v3
  v_bfe_u32 v4, v0, 5, 1
  v_lshl_add_u32 v2, v4, 8, v2
  v_lshlrev_b32 v3, 2, v3
  v_lshl_add_u32 v3, v4, 1, v3
  s_lshl_b32 s21, s20, 3
  s_add_u32 s21, s21, s22
  s_lshl_b32 s21, s21, 5
  s_add_u32 s21, s21, s3
  s_mul_i32 s21, s21, 1280
  s_lshl_b32 s23, s52, 5
  v_lshrrev_b32 v144, 1, v0
  v_and_b32 v145, 1, v0
  v_mul_u32_u24 v146, 7680, v144
  v_lshl_add_u32 v146, v145, 4, v146
  v_add_u32 v146, s23, v146
  v_lshlrev_b32 v147, 1, v144
  s_cmp_lt_u32 s2, 240
  s_cselect_b32 s49, 5, 0
  s_waitcnt lgkmcnt(0)
  s_mov_b32 s12, s6
  s_mov_b32 s13, s7
  s_mov_b32 s14, 31457280
  s_mov_b32 s15, 0x00020000
  s_mov_b32 s8, s56
  s_mov_b32 s9, s57
  s_mov_b32 s10, 1280
  s_mov_b32 s11, 0x00020000
  s_mov_b32 s16, s58
  s_mov_b32 s17, s59
  s_mov_b32 s18, 4915200
  s_mov_b32 s19, 0x00020000
  s_mov_b32 s24, s60
  s_mov_b32 s25, s61
  s_mov_b32 s26, 256
  s_mov_b32 s27, 0x00020000
  v_mov_b32 v20, 0
  s_lshr_b32 s23, s2, 3
  s_or_b32 s23, s23, s22
  s_cmp_lg_u32 s23, 0
  s_cbranch_scc1 KM_w_nn
  s_memrealtime s[38:39]
  s_waitcnt lgkmcnt(0)
  s_or_b32 s38, s38, 1
  v_mov_b32 v22, s38
  v_mov_b32 v23, 0
  s_mov_b64 exec, 1
  buffer_atomic_cmpswap v[22:23], v20, s[24:27], 0 offen sc1
  s_mov_b64 exec, -1
KM_w_nn:
  s_mov_b32 s24, s4
  s_mov_b32 s25, s5
  s_mov_b32 s26, 2621440
  s_mov_b32 s27, 0x00020000
  buffer_load_dwordx2 v[114:115], v2, s[24:27], s21 offen offset:0
  buffer_load_dwordx2 v[116:117], v2, s[24:27], s21 offen offset:512
  buffer_load_dwordx2 v[118:119], v2, s[24:27], s21 offen offset:1024
  s_cmp_ge_u32 s22, s49
  s_cbranch_scc1 KM_nog1a
  buffer_load_short_d16_hi v136, v147, s[8:11], 0 offen offset:0
  buffer_load_short_d16_hi v137, v147, s[8:11], 0 offen offset:320
  buffer_load_short_d16_hi v138, v147, s[8:11], 0 offen offset:640
  buffer_load_short_d16_hi v139, v147, s[8:11], 0 offen offset:960
  s_mov_b32 s23, 0
  buffer_load_dwordx4 v[120:123], v146, s[16:19], s23 offen
  s_add_u32 s23, s23, 1228800
  buffer_load_dwordx4 v[124:127], v146, s[16:19], s23 offen
  s_add_u32 s23, s23, 1228800
  buffer_load_dwordx4 v[128:131], v146, s[16:19], s23 offen
  s_add_u32 s23, s23, 1228800
  buffer_load_dwordx4 v[132:135], v146, s[16:19], s23 offen
KM_nog1a:
  v_and_b32 v5, 15, v0
  v_bfe_u32 v6, v0, 4, 2
  v_and_b32 v22, 7, v5
  s_lshl_b32 s40, s22, 3
  v_add_u32 v8, s40, v22
  v_cmp_eq_u32 vcc, 0, v8
  s_nop 1
  v_cndmask_b32 v10, 1.0, 0, vcc
  v_cmp_lt_u32 s[42:43], 7, v5
  s_nop 0
  s_and_b64 s[44:45], s[42:43], vcc
  s_andn2_b64 s[42:43], s[42:43], vcc
  v_cndmask_b32 v8, v8, 64, s[44:45]
  v_cndmask_b32 v9, 0, -1, s[42:43]
  v_sub_u32 v22, 128, v8
  v_cndmask_b32 v22, v8, v22, s[42:43]
  v_mul_u32_u24 v22, 5, v22
  v_lshrrev_b32 v23, 1, v6
  v_lshl_add_u32 v22, v23, 7, v22
  v_add_u32 v23, 128, v22
  v_subrev_u32 v24, 640, v23
  v_min_u32 v23, v23, v24
  v_sub_u32 v24, 640, v23
  v_cmp_lt_u32 vcc, v24, v23
  v_min_u32 v23, v23, v24
  v_mov_b32 v24, 0x80008000
  v_cndmask_b32 v12, 0, v24, vcc
  v_and_b32 v25, 1, v6
  v_lshlrev_b32 v25, 4, v25
  v_lshl_add_u32 v11, v23, 13, v25
  v_mul_u32_u24 v23, 40960, v8
  v_add_u32 v13, v23, v25
  s_lshl_b32 s40, s22, 5
  v_lshrrev_b32 v22, 1, v6
  v_lshl_add_u32 v22, v22, 4, v5
  v_add_u32 v22, s40, v22
  v_add_u32 v23, 256, v8
  v_and_b32 v24, 1, v6
  v_lshlrev_b32 v24, 7, v24
  v_lshrrev_b32 v25, 3, v22
  v_lshl_add_u32 v25, v25, 16, v24
  v_and_b32 v26, 7, v22
  v_lshl_add_u32 v11, v26, 4, v25
  v_lshrrev_b32 v25, 3, v23
  v_lshl_add_u32 v25, v25, 16, v24
  v_and_b32 v26, 7, v23
  v_lshl_add_u32 v13, v26, 4, v25
  s_lshl_b32 s38, s3, 11
  s_lshl_b32 s21, s20, 8
  s_add_u32 s38, s38, s21
  s_add_u32 s38, s38, 1048576
  v_mov_b32 v28, -1
  v_mov_b32 v29, -1
  v_mov_b32 v30, -1
  v_mov_b32 v31, -1
  buffer_store_dwordx4 v[28:31], v11, s[12:15], s38 offen sc1
  s_mov_b32 exec_lo, 0x00ff00ff
  s_mov_b32 exec_hi, 0
  buffer_store_dwordx4 v[28:31], v13, s[12:15], s38 offen sc1
  s_mov_b64 exec, -1
  s_lshl_b32 s38, s20, 3
  s_add_u32 s38, s38, s22
  s_lshl_b32 s21, s3, 6
  s_add_u32 s38, s38, s21
  s_mul_i32 s38, s38, 1280
  s_add_u32 s38, s38, 13631488
  buffer_store_dwordx2 v[28:29], v2, s[12:15], s38 offen sc1
  v_cvt_f32_u32 v22, v3
  v_mul_f32 v22, 0xbe4ccccd, v22
  v_add_f32 v23, 0xbe4ccccd, v22
  v_cos_f32 v88, v22
  v_cos_f32 v89, v23
  v_sin_f32 v90, v22
  v_sin_f32 v91, v23
  v_pk_add_f32 v[22:23], v[22:23], v[22:23]
  v_cos_f32 v92, v22
  v_cos_f32 v93, v23
  v_sin_f32 v94, v22
  v_sin_f32 v95, v23
  v_cvt_f32_u32 v22, v8
  v_mul_f32 v22, 0x3c000000, v22
  v_cvt_f32_u32 v23, v6
  v_mul_f32 v23, 0x41000000, v23
  v_and_b32 v24, 0x3e800000, v9
  v_fma_f32 v23, v23, v22, -v24
  v_mul_f32 v24, 0x41c80000, v22
  v_cos_f32 v25, v23
  v_add_f32 v23, v23, v22
  v_cos_f32 v26, v23
  v_add_f32 v23, v23, v22
  v_cvt_pk_bf16_f32 v96, v25, v26
  v_cos_f32 v25, v23
  v_add_f32 v23, v23, v22
  v_cos_f32 v26, v23
  v_add_f32 v23, v23, v22
  v_cvt_pk_bf16_f32 v97, v25, v26
  v_cos_f32 v25, v23
  v_add_f32 v23, v23, v22
  v_cos_f32 v26, v23
  v_add_f32 v23, v23, v22
  v_cvt_pk_bf16_f32 v98, v25, v26
  v_cos_f32 v25, v23
  v_add_f32 v23, v23, v22
  v_cos_f32 v26, v23
  v_add_f32 v23, v23, v24
  v_cvt_pk_bf16_f32 v99, v25, v26
  v_cos_f32 v25, v23
  v_add_f32 v23, v23, v22
  v_cos_f32 v26, v23
  v_add_f32 v23, v23, v22
  v_cvt_pk_bf16_f32 v100, v25, v26
  v_cos_f32 v25, v23
  v_add_f32 v23, v23, v22
  v_cos_f32 v26, v23
  v_add_f32 v23, v23, v22
  v_cvt_pk_bf16_f32 v101, v25, v26
  v_cos_f32 v25, v23
  v_add_f32 v23, v23, v22
  v_cos_f32 v26, v23
  v_add_f32 v23, v23, v22
  v_cvt_pk_bf16_f32 v102, v25, v26
  v_cos_f32 v25, v23
  v_add_f32 v23, v23, v22
  v_cos_f32 v26, v23
  v_add_f32 v23, v23, v24
  v_cvt_pk_bf16_f32 v103, v25, v26
  v_cos_f32 v25, v23
  v_add_f32 v23, v23, v22
  v_cos_f32 v26, v23
  v_add_f32 v23, v23, v22
  v_cvt_pk_bf16_f32 v104, v25, v26
  v_cos_f32 v25, v23
  v_add_f32 v23, v23, v22
  v_cos_f32 v26, v23
  v_add_f32 v23, v23, v22
  v_cvt_pk_bf16_f32 v105, v25, v26
  v_cos_f32 v25, v23
  v_add_f32 v23, v23, v22
  v_cos_f32 v26, v23
  v_add_f32 v23, v23, v22
  v_cvt_pk_bf16_f32 v106, v25, v26
  v_cos_f32 v25, v23
  v_add_f32 v23, v23, v22
  v_cos_f32 v26, v23
  v_add_f32 v23, v23, v24
  v_cvt_pk_bf16_f32 v107, v25, v26
  v_cos_f32 v25, v23
  v_add_f32 v23, v23, v22
  v_cos_f32 v26, v23
  v_add_f32 v23, v23, v22
  v_cvt_pk_bf16_f32 v108, v25, v26
  v_cos_f32 v25, v23
  v_add_f32 v23, v23, v22
  v_cos_f32 v26, v23
  v_add_f32 v23, v23, v22
  v_cvt_pk_bf16_f32 v109, v25, v26
  v_cos_f32 v25, v23
  v_add_f32 v23, v23, v22
  v_cos_f32 v26, v23
  v_add_f32 v23, v23, v22
  v_cvt_pk_bf16_f32 v110, v25, v26
  v_cos_f32 v25, v23
  v_add_f32 v23, v23, v22
  v_cos_f32 v26, v23
  v_add_f32 v23, v23, v24
  v_cvt_pk_bf16_f32 v111, v25, v26
  v_lshrrev_b32 v22, 3, v3
  v_xor_b32 v22, s22, v22
  v_lshlrev_b32 v22, 4, v22
  v_and_b32 v23, 7, v3
  v_lshl_add_u32 v22, v23, 1, v22
  s_lshl_b32 s23, s22, 8
  s_add_u32 s23, s23, 106496
  v_add_u32 v14, s23, v22
  v_xor_b32 v15, 2176, v14
  v_lshlrev_b32 v7, 2, v3
  v_add_u32 v7, 100352, v7
  v_xor_b32 v22, v6, v5
  v_xor_b32 v23, 0, v22
  v_lshlrev_b32 v23, 4, v23
  v_lshl_add_u32 v23, v5, 8, v23
  v_add_u32 v16, 106496, v23
  v_xor_b32 v23, 4, v22
  v_lshlrev_b32 v23, 4, v23
  v_lshl_add_u32 v23, v5, 8, v23
  v_add_u32 v17, 106496, v23
  v_xor_b32 v23, 8, v22
  v_lshlrev_b32 v23, 4, v23
  v_lshl_add_u32 v23, v5, 8, v23
  v_add_u32 v18, 106496, v23
  v_xor_b32 v23, 12, v22
  v_lshlrev_b32 v23, 4, v23
  v_lshl_add_u32 v23, v5, 8, v23
  v_add_u32 v19, 106496, v23
  s_mov_b32 s30, 0x3e9e377a
  s_mov_b32 s31, 0x3e9e377a
  s_mov_b32 s32, 0xbf4f1bbd
  s_mov_b32 s33, 0xbf4f1bbd
  s_mov_b32 s34, 0x3f737871
  s_mov_b32 s35, 0x3f737871
  s_mov_b32 s36, 0x3f167918
  s_mov_b32 s37, 0x3f167918
  s_mov_b32 s24, s60
  s_mov_b32 s25, s61
  s_mov_b32 s26, 256
  s_mov_b32 s27, 0x00020000
  s_cmp_lg_u32 s22, 7
  s_cbranch_scc1 KM_w_nl
  buffer_load_dword v21, v20, s[24:27], 0 offen sc1
KM_w_nl:
  s_waitcnt vmcnt(11)
  s_cmp_lt_u32 s22, s49
  s_cbranch_scc1 KM_x0
  s_waitcnt vmcnt(3)
KM_x0:
  v_permlane32_swap_b32 v114, v115
  v_permlane32_swap_b32 v116, v117
  v_permlane32_swap_b32 v118, v119
  v_lshlrev_b32 v60, 16, v114
  v_and_b32 v61, 0xffff0000, v114
  v_lshlrev_b32 v62, 16, v115
  v_and_b32 v63, 0xffff0000, v115
  v_lshlrev_b32 v64, 16, v116
  v_and_b32 v65, 0xffff0000, v116
  v_lshlrev_b32 v66, 16, v117
  v_and_b32 v67, 0xffff0000, v117
  v_lshlrev_b32 v68, 16, v118
  v_and_b32 v69, 0xffff0000, v118
  v_pk_add_f32 v[70:71], v[60:61], v[62:63]
  v_pk_add_f32 v[72:73], v[64:65], v[66:67]
  v_pk_add_f32 v[70:71], v[70:71], v[68:69]
  v_pk_add_f32 v[70:71], v[70:71], v[72:73]
  v_add_f32 v70, v70, v71
  s_nop 1
  v_add_f32_dpp v70, v70, v70 quad_perm:[1,0,3,2] row_mask:0xf bank_mask:0xf
  s_nop 1
  v_add_f32_dpp v70, v70, v70 quad_perm:[2,3,0,1] row_mask:0xf bank_mask:0xf
  s_nop 1
  v_add_f32_dpp v70, v70, v70 row_ror:4 row_mask:0xf bank_mask:0xf
  s_nop 1
  v_add_f32_dpp v70, v70, v70 row_ror:8 row_mask:0xf bank_mask:0xf
  v_mov_b32 v71, v70
  s_nop 1
  v_permlane16_swap_b32 v70, v71
  v_add_f32 v70, v70, v71
  v_mov_b32 v71, v70
  s_nop 1
  v_permlane32_swap_b32 v70, v71
  v_add_f32 v70, v70, v71
  v_mul_f32 v70, 0xbacccccd, v70
  v_pk_add_f32 v[60:61], v[60:61], v[70:71] op_sel_hi:[1,0]
  v_pk_add_f32 v[62:63], v[62:63], v[70:71] op_sel_hi:[1,0]
  v_pk_add_f32 v[64:65], v[64:65], v[70:71] op_sel_hi:[1,0]
  v_pk_add_f32 v[66:67], v[66:67], v[70:71] op_sel_hi:[1,0]
  v_pk_add_f32 v[68:69], v[68:69], v[70:71] op_sel_hi:[1,0]
  v_pk_mul_f32 v[70:71], v[60:61], v[60:61]
  v_pk_mul_f32 v[72:73], v[62:63], v[62:63]
  v_pk_fma_f32 v[70:71], v[64:65], v[64:65], v[70:71]
  v_pk_fma_f32 v[72:73], v[66:67], v[66:67], v[72:73]
  v_pk_fma_f32 v[70:71], v[68:69], v[68:69], v[70:71]
  v_pk_add_f32 v[70:71], v[70:71], v[72:73]
  v_add_f32 v70, v70, v71
  s_nop 1
  v_add_f32_dpp v70, v70, v70 quad_perm:[1,0,3,2] row_mask:0xf bank_mask:0xf
  s_nop 1
  v_add_f32_dpp v70, v70, v70 quad_perm:[2,3,0,1] row_mask:0xf bank_mask:0xf
  s_nop 1
  v_add_f32_dpp v70, v70, v70 row_ror:4 row_mask:0xf bank_mask:0xf
  s_nop 1
  v_add_f32_dpp v70, v70, v70 row_ror:8 row_mask:0xf bank_mask:0xf
  v_mov_b32 v71, v70
  s_nop 1
  v_permlane16_swap_b32 v70, v71
  v_add_f32 v70, v70, v71
  v_mov_b32 v71, v70
  s_nop 1
  v_permlane32_swap_b32 v70, v71
  v_add_f32 v70, v70, v71
  v_mov_b32 v71, 0x3727c5ac
  v_fmac_f32 v71, 0x3acccccd, v70
  v_rsq_f32 v70, v71
  s_cmp_ge_u32 s22, s49
  s_cbranch_scc1 KM_nog2
  s_waitcnt vmcnt(7)
  v_mul_f32 v140, 0xbfb8aa3b, v136
  v_mul_f32 v141, 0xbfb8aa3b, v137
  v_mul_f32 v142, 0xbfb8aa3b, v138
  v_mul_f32 v143, 0xbfb8aa3b, v139
  v_exp_f32 v140, v140
  v_exp_f32 v141, v141
  v_exp_f32 v142, v142
  v_exp_f32 v143, v143
  v_add_f32 v140, 1.0, v140
  v_add_f32 v141, 1.0, v141
  v_add_f32 v142, 1.0, v142
  v_add_f32 v143, 1.0, v143
  v_rcp_f32 v140, v140
  v_rcp_f32 v141, v141
  v_rcp_f32 v142, v142
  v_rcp_f32 v143, v143
  v_mul_f32 v136, v136, v140
  v_mul_f32 v137, v137, v141
  v_mul_f32 v138, v138, v142
  v_mul_f32 v139, v139, v143
  v_cvt_pk_bf16_f32 v136, v136, v136
  v_cvt_pk_bf16_f32 v137, v137, v137
  v_cvt_pk_bf16_f32 v138, v138, v138
  v_cvt_pk_bf16_f32 v139, v139, v139
  v_and_b32 v48, 0xffff0000, v136
  v_and_b32 v50, 0xffff0000, v137
  v_and_b32 v52, 0xffff0000, v138
  v_and_b32 v54, 0xffff0000, v139
  v_lshrrev_b32 v22, 4, v0
  v_lshlrev_b32 v23, 6, v22
  v_lshl_add_u32 v23, v145, 5, v23
  v_add_u32 v23, 98304, v23
  s_waitcnt vmcnt(6)
  v_lshlrev_b32 v32, 16, v120
  v_and_b32 v33, 0xffff0000, v120
  v_lshlrev_b32 v34, 16, v121
  v_and_b32 v35, 0xffff0000, v121
  v_lshlrev_b32 v36, 16, v122
  v_and_b32 v37, 0xffff0000, v122
  v_lshlrev_b32 v38, 16, v123
  v_and_b32 v39, 0xffff0000, v123
  v_pk_mul_f32 v[40:41], v[32:33], v[48:49] op_sel_hi:[1,0]
  v_pk_mul_f32 v[42:43], v[34:35], v[48:49] op_sel_hi:[1,0]
  v_pk_mul_f32 v[44:45], v[36:37], v[48:49] op_sel_hi:[1,0]
  v_pk_mul_f32 v[46:47], v[38:39], v[48:49] op_sel_hi:[1,0]
  s_waitcnt vmcnt(5)
  v_lshlrev_b32 v32, 16, v124
  v_and_b32 v33, 0xffff0000, v124
  v_lshlrev_b32 v34, 16, v125
  v_and_b32 v35, 0xffff0000, v125
  v_lshlrev_b32 v36, 16, v126
  v_and_b32 v37, 0xffff0000, v126
  v_lshlrev_b32 v38, 16, v127
  v_and_b32 v39, 0xffff0000, v127
  v_pk_fma_f32 v[40:41], v[32:33], v[50:51], v[40:41] op_sel_hi:[1,0,1]
  v_pk_fma_f32 v[42:43], v[34:35], v[50:51], v[42:43] op_sel_hi:[1,0,1]
  v_pk_fma_f32 v[44:45], v[36:37], v[50:51], v[44:45] op_sel_hi:[1,0,1]
  v_pk_fma_f32 v[46:47], v[38:39], v[50:51], v[46:47] op_sel_hi:[1,0,1]
  s_waitcnt vmcnt(4)
  v_lshlrev_b32 v32, 16, v128
  v_and_b32 v33, 0xffff0000, v128
  v_lshlrev_b32 v34, 16, v129
  v_and_b32 v35, 0xffff0000, v129
  v_lshlrev_b32 v36, 16, v130
  v_and_b32 v37, 0xffff0000, v130
  v_lshlrev_b32 v38, 16, v131
  v_and_b32 v39, 0xffff0000, v131
  v_pk_fma_f32 v[40:41], v[32:33], v[52:53], v[40:41] op_sel_hi:[1,0,1]
  v_pk_fma_f32 v[42:43], v[34:35], v[52:53], v[42:43] op_sel_hi:[1,0,1]
  v_pk_fma_f32 v[44:45], v[36:37], v[52:53], v[44:45] op_sel_hi:[1,0,1]
  v_pk_fma_f32 v[46:47], v[38:39], v[52:53], v[46:47] op_sel_hi:[1,0,1]
  s_waitcnt vmcnt(3)
  v_lshlrev_b32 v32, 16, v132
  v_and_b32 v33, 0xffff0000, v132
  v_lshlrev_b32 v34, 16, v133
  v_and_b32 v35, 0xffff0000, v133
  v_lshlrev_b32 v36, 16, v134
  v_and_b32 v37, 0xffff0000, v134
  v_lshlrev_b32 v38, 16, v135
  v_and_b32 v39, 0xffff0000, v135
  v_pk_fma_f32 v[40:41], v[32:33], v[54:55], v[40:41] op_sel_hi:[1,0,1]
  v_pk_fma_f32 v[42:43], v[34:35], v[54:55], v[42:43] op_sel_hi:[1,0,1]
  v_pk_fma_f32 v[44:45], v[36:37], v[54:55], v[44:45] op_sel_hi:[1,0,1]
  v_pk_fma_f32 v[46:47], v[38:39], v[54:55], v[46:47] op_sel_hi:[1,0,1]
  v_add_f32_dpp v40, v40, v40 quad_perm:[2,3,0,1] row_mask:0xf bank_mask:0xf
  v_add_f32_dpp v41, v41, v41 quad_perm:[2,3,0,1] row_mask:0xf bank_mask:0xf
  v_add_f32_dpp v42, v42, v42 quad_perm:[2,3,0,1] row_mask:0xf bank_mask:0xf
  v_add_f32_dpp v43, v43, v43 quad_perm:[2,3,0,1] row_mask:0xf bank_mask:0xf
  v_add_f32_dpp v44, v44, v44 quad_perm:[2,3,0,1] row_mask:0xf bank_mask:0xf
  v_add_f32_dpp v45, v45, v45 quad_perm:[2,3,0,1] row_mask:0xf bank_mask:0xf
  v_add_f32_dpp v46, v46, v46 quad_perm:[2,3,0,1] row_mask:0xf bank_mask:0xf
  v_add_f32_dpp v47, v47, v47 quad_perm:[2,3,0,1] row_mask:0xf bank_mask:0xf
  v_add_f32_dpp v40, v40, v40 row_ror:4 row_mask:0xf bank_mask:0xf
  v_add_f32_dpp v41, v41, v41 row_ror:4 row_mask:0xf bank_mask:0xf
  v_add_f32_dpp v42, v42, v42 row_ror:4 row_mask:0xf bank_mask:0xf
  v_add_f32_dpp v43, v43, v43 row_ror:4 row_mask:0xf bank_mask:0xf
  v_add_f32_dpp v44, v44, v44 row_ror:4 row_mask:0xf bank_mask:0xf
  v_add_f32_dpp v45, v45, v45 row_ror:4 row_mask:0xf bank_mask:0xf
  v_add_f32_dpp v46, v46, v46 row_ror:4 row_mask:0xf bank_mask:0xf
  v_add_f32_dpp v47, v47, v47 row_ror:4 row_mask:0xf bank_mask:0xf
  v_add_f32_dpp v40, v40, v40 row_ror:8 row_mask:0xf bank_mask:0xf
  v_add_f32_dpp v41, v41, v41 row_ror:8 row_mask:0xf bank_mask:0xf
  v_add_f32_dpp v42, v42, v42 row_ror:8 row_mask:0xf bank_mask:0xf
  v_add_f32_dpp v43, v43, v43 row_ror:8 row_mask:0xf bank_mask:0xf
  v_add_f32_dpp v44, v44, v44 row_ror:8 row_mask:0xf bank_mask:0xf
  v_add_f32_dpp v45, v45, v45 row_ror:8 row_mask:0xf bank_mask:0xf
  v_add_f32_dpp v46, v46, v46 row_ror:8 row_mask:0xf bank_mask:0xf
  v_add_f32_dpp v47, v47, v47 row_ror:8 row_mask:0xf bank_mask:0xf
  v_cmp_gt_u32 vcc, 2, v5
  s_nop 0
  s_and_saveexec_b64 s[38:39], vcc
  ds_write_b128 v23, v[40:43]
  ds_write_b128 v23, v[44:47] offset:16
  s_mov_b64 exec, s[38:39]
KM_nog2:
  s_waitcnt vmcnt(0)
  s_cmp_lg_u32 s22, 7
  s_cbranch_scc1 KM_w_nw
  v_cmp_ne_u32 vcc, 0, v21
  s_nop 1
  s_cmp_lg_u64 vcc, 0
  s_cbranch_scc1 KM_wn_ok
  s_mov_b32 s46, 0x8000
KM_wn:
  buffer_load_dword v21, v20, s[24:27], 0 offen sc1
  s_waitcnt vmcnt(0)
  v_cmp_eq_u32 vcc, 0, v21
  s_nop 1
  s_and_b64 exec, exec, vcc
  s_cbranch_scc0 KM_wn_ok
  s_sleep 4
  s_sub_u32 s46, s46, 1
  s_cmp_lg_u32 s46, 0
  s_cbranch_scc1 KM_wn
KM_wn_ok:
  s_mov_b64 exec, -1
  v_mov_b32 v22, 99840
  ds_write_b32 v22, v21
KM_w_nw:
  s_waitcnt lgkmcnt(0)
  s_barrier
  v_mov_b32 v22, 99840
  ds_read_b32 v21, v22
  s_cmp_lg_u32 s22, 0
  s_cbranch_scc1 KM_nog3
  s_cmp_eq_u32 s49, 0
  s_cbranch_scc1 KM_nog3
  v_mul_u32_u24 v23, 320, v6
  v_lshl_add_u32 v23, v5, 2, v23
  v_add_u32 v23, 98304, v23
  ds_read_b32 v40, v23
  ds_read_b32 v41, v23 offset:64
  ds_read_b32 v42, v23 offset:128
  ds_read_b32 v43, v23 offset:192
  ds_read_b32 v44, v23 offset:256
  s_sub_u32 s23, s52, 40
  s_cmp_lt_u32 s23, 40
  s_cselect_b32 s21, 1.0, 0
  s_sub_u32 s23, s52, 160
  s_cmp_lt_u32 s23, 40
  s_cselect_b32 s21, 1.0, s21
  s_waitcnt lgkmcnt(0)
  v_add_f32 v40, v40, v41
  v_add_f32 v42, v42, v43
  v_add_f32 v40, v40, v44
  v_add_f32 v40, v40, v42
  v_mov_b32 v41, v40
  s_nop 1
  v_permlane16_swap_b32 v40, v41
  v_add_f32 v40, v40, v41
  v_mov_b32 v41, v40
  s_nop 1
  v_permlane32_swap_b32 v40, v41
  v_add_f32 v40, v40, v41
  v_cvt_pk_bf16_f32 v40, v40, v40
  v_and_b32 v40, 0xffff0000, v40
  v_add_f32 v40, s21, v40
  v_cvt_pk_bf16_f32 v40, v40, v40
  v_and_b32 v40, 0xffff0000, v40
  v_mov_b32 v41, v21
  s_mov_b64 exec, 0xffff
  s_cmp_lt_u32 s52, 80
  s_cbranch_scc1 KM_gran
  s_lshl_b32 s23, s52, 6
  v_lshlrev_b32 v23, 2, v1
  buffer_store_dword v40, v23, s[12:15], s23 offen sc1
  s_branch KM_pub
KM_gran:
  s_lshl_b32 s23, s52, 7
  s_add_u32 s23, s23, 16384
  v_lshlrev_b32 v23, 3, v1
  buffer_store_dwordx2 v[40:41], v23, s[12:15], s23 offen sc1
KM_pub:
  s_mov_b64 exec, -1
KM_nog3:
  v_bfe_u32 v46, v0, 6, 2
  v_lshl_add_u32 v46, v46, 4, v5
  v_cvt_f32_u32 v46, v46
  v_cvt_f32_u32 v47, v6
  v_cvt_f32_u32 v48, v5
  v_mul_f32 v47, 4.0, v47
  v_mul_f32 v49, 0x3c800000, v46
  v_mul_f32 v50, v47, v49
  v_mul_f32 v51, 0x41500000, v49
  v_cos_f32 v52, v50
  v_sin_f32 v53, v50
  v_add_f32 v50, v50, v49
  v_cos_f32 v54, v50
  v_sin_f32 v55, v50
  v_add_f32 v50, v50, v49
  v_cvt_pk_bf16_f32 v122, v52, v54
  v_cvt_pk_bf16_f32 v120, -v53, -v55
  v_cvt_pk_bf16_f32 v124, v53, v55
  v_cos_f32 v52, v50
  v_sin_f32 v53, v50
  v_add_f32 v50, v50, v49
  v_cos_f32 v54, v50
  v_sin_f32 v55, v50
  v_add_f32 v50, v50, v51
  v_cvt_pk_bf16_f32 v123, v52, v54
  v_cvt_pk_bf16_f32 v121, -v53, -v55
  v_cvt_pk_bf16_f32 v125, v53, v55
  v_cos_f32 v52, v50
  v_sin_f32 v53, v50
  v_add_f32 v50, v50, v49
  v_cos_f32 v54, v50
  v_sin_f32 v55, v50
  v_add_f32 v50, v50, v49
  v_cvt_pk_bf16_f32 v128, v52, v54
  v_cvt_pk_bf16_f32 v126, -v53, -v55
  v_cvt_pk_bf16_f32 v130, v53, v55
  v_cos_f32 v52, v50
  v_sin_f32 v53, v50
  v_add_f32 v50, v50, v49
  v_cos_f32 v54, v50
  v_sin_f32 v55, v50
  v_add_f32 v50, v50, v51
  v_cvt_pk_bf16_f32 v129, v52, v54
  v_cvt_pk_bf16_f32 v127, -v53, -v55
  v_cvt_pk_bf16_f32 v131, v53, v55
  v_cos_f32 v52, v50
  v_sin_f32 v53, v50
  v_add_f32 v50, v50, v49
  v_cos_f32 v54, v50
  v_sin_f32 v55, v50
  v_add_f32 v50, v50, v49
  v_cvt_pk_bf16_f32 v134, v52, v54
  v_cvt_pk_bf16_f32 v132, -v53, -v55
  v_cvt_pk_bf16_f32 v136, v53, v55
  v_cos_f32 v52, v50
  v_sin_f32 v53, v50
  v_add_f32 v50, v50, v49
  v_cos_f32 v54, v50
  v_sin_f32 v55, v50
  v_add_f32 v50, v50, v51
  v_cvt_pk_bf16_f32 v135, v52, v54
  v_cvt_pk_bf16_f32 v133, -v53, -v55
  v_cvt_pk_bf16_f32 v137, v53, v55
  v_cos_f32 v52, v50
  v_sin_f32 v53, v50
  v_add_f32 v50, v50, v49
  v_cos_f32 v54, v50
  v_sin_f32 v55, v50
  v_add_f32 v50, v50, v49
  v_cvt_pk_bf16_f32 v140, v52, v54
  v_cvt_pk_bf16_f32 v138, -v53, -v55
  v_cvt_pk_bf16_f32 v142, v53, v55
  v_cos_f32 v52, v50
  v_sin_f32 v53, v50
  v_add_f32 v50, v50, v49
  v_cos_f32 v54, v50
  v_sin_f32 v55, v50
  v_add_f32 v50, v50, v51
  v_cvt_pk_bf16_f32 v141, v52, v54
  v_cvt_pk_bf16_f32 v139, -v53, -v55
  v_cvt_pk_bf16_f32 v143, v53, v55
  v_add_f32 v49, 0x00000000, v48
  v_mul_f32 v49, 0x3d000000, v49
  v_mul_f32 v50, v47, v49
  v_mul_f32 v51, 0x41500000, v49
  v_cos_f32 v52, v50
  v_sin_f32 v53, v50
  v_add_f32 v50, v50, v49
  v_cos_f32 v54, v50
  v_sin_f32 v55, v50
  v_add_f32 v50, v50, v49
  v_cvt_pk_bf16_f32 v146, v52, v54
  v_cvt_pk_bf16_f32 v144, -v53, -v55
  v_cvt_pk_bf16_f32 v148, v53, v55
  v_cos_f32 v52, v50
  v_sin_f32 v53, v50
  v_add_f32 v50, v50, v49
  v_cos_f32 v54, v50
  v_sin_f32 v55, v50
  v_add_f32 v50, v50, v51
  v_cvt_pk_bf16_f32 v147, v52, v54
  v_cvt_pk_bf16_f32 v145, -v53, -v55
  v_cvt_pk_bf16_f32 v149, v53, v55
  v_cos_f32 v52, v50
  v_sin_f32 v53, v50
  v_add_f32 v50, v50, v49
  v_cos_f32 v54, v50
  v_sin_f32 v55, v50
  v_add_f32 v50, v50, v49
  v_cvt_pk_bf16_f32 v152, v52, v54
  v_cvt_pk_bf16_f32 v150, -v53, -v55
  v_cvt_pk_bf16_f32 v154, v53, v55
  v_cos_f32 v52, v50
  v_sin_f32 v53, v50
  v_add_f32 v50, v50, v49
  v_cos_f32 v54, v50
  v_sin_f32 v55, v50
  v_add_f32 v50, v50, v51
  v_cvt_pk_bf16_f32 v153, v52, v54
  v_cvt_pk_bf16_f32 v151, -v53, -v55
  v_cvt_pk_bf16_f32 v155, v53, v55
  v_add_f32 v49, 0x41800000, v48
  v_mul_f32 v49, 0x3d000000, v49
  v_mul_f32 v50, v47, v49
  v_mul_f32 v51, 0x41500000, v49
  v_cos_f32 v52, v50
  v_sin_f32 v53, v50
  v_add_f32 v50, v50, v49
  v_cos_f32 v54, v50
  v_sin_f32 v55, v50
  v_add_f32 v50, v50, v49
  v_cvt_pk_bf16_f32 v158, v52, v54
  v_cvt_pk_bf16_f32 v156, -v53, -v55
  v_cvt_pk_bf16_f32 v160, v53, v55
  v_cos_f32 v52, v50
  v_sin_f32 v53, v50
  v_add_f32 v50, v50, v49
  v_cos_f32 v54, v50
  v_sin_f32 v55, v50
  v_add_f32 v50, v50, v51
  v_cvt_pk_bf16_f32 v159, v52, v54
  v_cvt_pk_bf16_f32 v157, -v53, -v55
  v_cvt_pk_bf16_f32 v161, v53, v55
  v_cos_f32 v52, v50
  v_sin_f32 v53, v50
  v_add_f32 v50, v50, v49
  v_cos_f32 v54, v50
  v_sin_f32 v55, v50
  v_add_f32 v50, v50, v49
  v_cvt_pk_bf16_f32 v164, v52, v54
  v_cvt_pk_bf16_f32 v162, -v53, -v55
  v_cvt_pk_bf16_f32 v166, v53, v55
  v_cos_f32 v52, v50
  v_sin_f32 v53, v50
  v_add_f32 v50, v50, v49
  v_cos_f32 v54, v50
  v_sin_f32 v55, v50
  v_add_f32 v50, v50, v51
  v_cvt_pk_bf16_f32 v165, v52, v54
  v_cvt_pk_bf16_f32 v163, -v53, -v55
  v_cvt_pk_bf16_f32 v167, v53, v55
  s_lshl_b32 s23, s3, 11
  s_lshl_b32 s21, s20, 8
  s_add_u32 s23, s23, s21
  s_add_u32 s23, s23, 1048576
  s_barrier
  ds_read_b64 v[40:41], v7 offset:2560
  ds_read_b64 v[50:51], v7 offset:0
  ds_read_b64 v[42:43], v7 offset:3072
  ds_read_b64 v[52:53], v7 offset:512
  ds_read_b64 v[44:45], v7 offset:3584
  ds_read_b64 v[54:55], v7 offset:1024
  ds_read_b64 v[46:47], v7 offset:4096
  ds_read_b64 v[56:57], v7 offset:1536
  ds_read_b64 v[48:49], v7 offset:4608
  ds_read_b64 v[58:59], v7 offset:2048
  v_pk_mul_f32 v[28:29], v[60:61], v[70:71] op_sel_hi:[1,0]
  v_pk_mul_f32 v[30:31], v[62:63], v[70:71] op_sel_hi:[1,0]
  v_pk_mul_f32 v[32:33], v[64:65], v[70:71] op_sel_hi:[1,0]
  v_pk_mul_f32 v[34:35], v[66:67], v[70:71] op_sel_hi:[1,0]
  v_pk_mul_f32 v[36:37], v[68:69], v[70:71] op_sel_hi:[1,0]
  s_waitcnt lgkmcnt(0)
  v_pk_fma_f32 v[28:29], v[28:29], v[40:41], v[50:51]
  v_pk_fma_f32 v[30:31], v[30:31], v[42:43], v[52:53]
  v_pk_fma_f32 v[32:33], v[32:33], v[44:45], v[54:55]
  v_pk_fma_f32 v[34:35], v[34:35], v[46:47], v[56:57]
  v_pk_fma_f32 v[36:37], v[36:37], v[48:49], v[58:59]
  v_pk_add_f32 v[40:41], v[32:33], v[34:35]
  v_pk_add_f32 v[42:43], v[36:37], v[30:31]
  v_pk_add_f32 v[44:45], v[32:33], v[34:35] neg_lo:[0,1] neg_hi:[0,1]
  v_pk_add_f32 v[46:47], v[36:37], v[30:31] neg_lo:[0,1] neg_hi:[0,1]
  v_pk_add_f32 v[48:49], v[28:29], v[40:41]
  v_pk_fma_f32 v[50:51], s[30:31], v[40:41], v[28:29]
  v_pk_fma_f32 v[54:55], s[32:33], v[40:41], v[28:29]
  v_pk_mul_f32 v[52:53], s[34:35], v[44:45]
  v_pk_mul_f32 v[56:57], s[36:37], v[44:45]
  v_pk_add_f32 v[48:49], v[48:49], v[42:43]
  v_pk_fma_f32 v[50:51], s[32:33], v[42:43], v[50:51]
  v_pk_fma_f32 v[54:55], s[30:31], v[42:43], v[54:55]
  v_pk_fma_f32 v[52:53], s[36:37], v[46:47], v[52:53]
  v_pk_fma_f32 v[56:57], s[34:35], v[46:47], v[56:57] neg_lo:[0,1,0] neg_hi:[0,1,0]
  v_cvt_pk_bf16_f32 v22, v48, v49
  ds_write_b32 v14, v22 offset:8192
  v_pk_mul_f32 v[28:29], v[50:51], v[88:89]
  v_pk_mul_f32 v[30:31], v[50:51], v[90:91]
  v_pk_fma_f32 v[28:29], v[52:53], v[90:91], v[28:29]
  v_pk_fma_f32 v[30:31], v[52:53], v[88:89], v[30:31] neg_lo:[1,0,0] neg_hi:[1,0,0]
  v_cvt_pk_bf16_f32 v23, v28, v29
  v_cvt_pk_bf16_f32 v24, v30, v31
  ds_write_b32 v14, v23
  ds_write_b32 v14, v24 offset:4096
  v_pk_mul_f32 v[32:33], v[54:55], v[92:93]
  v_pk_mul_f32 v[34:35], v[54:55], v[94:95]
  v_pk_fma_f32 v[32:33], v[56:57], v[94:95], v[32:33]
  v_pk_fma_f32 v[34:35], v[56:57], v[92:93], v[34:35] neg_lo:[1,0,0] neg_hi:[1,0,0]
  v_cvt_pk_bf16_f32 v25, v32, v33
  v_cvt_pk_bf16_f32 v26, v34, v35
  ds_write_b32 v15, v25
  ds_write_b32 v15, v26 offset:4096
  s_waitcnt vmcnt(0) lgkmcnt(0)
  s_barrier
  ds_read_b128 v[28:31], v16 offset:0
  ds_read_b128 v[32:35], v17 offset:0
  ds_read_b128 v[36:39], v18 offset:0
  ds_read_b128 v[40:43], v19 offset:0
  ds_read_b128 v[44:47], v16 offset:4096
  ds_read_b128 v[48:51], v17 offset:4096
  ds_read_b128 v[52:55], v18 offset:4096
  ds_read_b128 v[56:59], v19 offset:4096
  ds_read_b128 v[60:63], v16 offset:8192
  ds_read_b128 v[64:67], v17 offset:8192
  ds_read_b128 v[68:71], v18 offset:8192
  ds_read_b128 v[72:75], v19 offset:8192
  s_waitcnt lgkmcnt(11)
  v_mfma_f32_16x16x32_bf16 v[76:79], v[28:31], v[96:99], 0
  s_waitcnt lgkmcnt(10)
  v_mfma_f32_16x16x32_bf16 v[76:79], v[32:35], v[100:103], v[76:79]
  s_waitcnt lgkmcnt(9)
  v_mfma_f32_16x16x32_bf16 v[76:79], v[36:39], v[104:107], v[76:79]
  s_waitcnt lgkmcnt(8)
  v_mfma_f32_16x16x32_bf16 v[76:79], v[40:43], v[108:111], v[76:79]
  s_waitcnt lgkmcnt(7)
  v_mfma_f32_16x16x32_bf16 v[80:83], v[44:47], v[96:99], 0
  s_waitcnt lgkmcnt(6)
  v_mfma_f32_16x16x32_bf16 v[80:83], v[48:51], v[100:103], v[80:83]
  s_waitcnt lgkmcnt(5)
  v_mfma_f32_16x16x32_bf16 v[80:83], v[52:55], v[104:107], v[80:83]
  s_waitcnt lgkmcnt(4)
  v_mfma_f32_16x16x32_bf16 v[80:83], v[56:59], v[108:111], v[80:83]
  s_waitcnt lgkmcnt(3)
  v_mfma_f32_16x16x32_bf16 v[84:87], v[60:63], v[96:99], 0
  s_waitcnt lgkmcnt(2)
  v_mfma_f32_16x16x32_bf16 v[84:87], v[64:67], v[100:103], v[84:87]
  s_waitcnt lgkmcnt(1)
  v_mfma_f32_16x16x32_bf16 v[84:87], v[68:71], v[104:107], v[84:87]
  s_waitcnt lgkmcnt(0)
  v_mfma_f32_16x16x32_bf16 v[84:87], v[72:75], v[108:111], v[84:87]
  v_and_b32 v22, 0x80008000, v9
  v_and_b32 v23, v9, v12
  v_bfi_b32 v24, v9, v22, v12
  v_pk_mul_f32 v[28:29], v[76:77], v[10:11] op_sel_hi:[1,0]
  v_pk_mul_f32 v[30:31], v[78:79], v[10:11] op_sel_hi:[1,0]
  v_pk_mul_f32 v[32:33], v[80:81], v[10:11] op_sel_hi:[1,0]
  v_pk_mul_f32 v[34:35], v[82:83], v[10:11] op_sel_hi:[1,0]
  s_nop 0
  v_add_f32_dpp v76, v32, v76 row_ror:8 row_mask:0xf bank_mask:0xf
  v_subrev_f32_dpp v80, v28, v80 row_ror:8 row_mask:0xf bank_mask:0xf
  v_add_f32_dpp v77, v33, v77 row_ror:8 row_mask:0xf bank_mask:0xf
  v_subrev_f32_dpp v81, v29, v81 row_ror:8 row_mask:0xf bank_mask:0xf
  v_add_f32_dpp v78, v34, v78 row_ror:8 row_mask:0xf bank_mask:0xf
  v_subrev_f32_dpp v82, v30, v82 row_ror:8 row_mask:0xf bank_mask:0xf
  v_add_f32_dpp v79, v35, v79 row_ror:8 row_mask:0xf bank_mask:0xf
  v_subrev_f32_dpp v83, v31, v83 row_ror:8 row_mask:0xf bank_mask:0xf
  v_cvt_pk_bf16_f32 v36, v76, v77
  v_cvt_pk_bf16_f32 v37, v78, v79
  v_cvt_pk_bf16_f32 v38, v80, v81
  v_cvt_pk_bf16_f32 v39, v82, v83
  v_cvt_pk_bf16_f32 v44, v84, v85
  v_cvt_pk_bf16_f32 v45, v86, v87
  v_xor_b32 v36, v36, v23
  v_xor_b32 v37, v37, v23
  v_xor_b32 v38, v38, v24
  v_xor_b32 v39, v39, v24
  v_xor_b32 v44, v44, v22
  v_xor_b32 v45, v45, v22
  v_cndmask_b32 v40, v36, v38, s[42:43]
  v_cndmask_b32 v41, v37, v39, s[42:43]
  v_cndmask_b32 v42, v38, v36, s[42:43]
  v_cndmask_b32 v43, v39, v37, s[42:43]
  buffer_store_dwordx4 v[40:43], v11, s[12:15], s23 offen sc1
  v_mov_b32_dpp v46, v44 row_ror:8 row_mask:0xf bank_mask:0xf
  v_mov_b32_dpp v47, v45 row_ror:8 row_mask:0xf bank_mask:0xf
  s_mov_b32 exec_lo, 0x00ff00ff
  s_mov_b32 exec_hi, 0
  buffer_store_dwordx4 v[44:47], v13, s[12:15], s23 offen sc1
  s_mov_b64 exec, -1
  s_lshr_b32 s26, s22, 2
  s_and_b32 s27, s22, 3
  s_lshl_b32 s28, s26, 2
  s_lshr_b32 s29, s2, 6
  s_add_u32 s28, s28, s29
  s_lshl_b32 s28, s28, 3
  s_and_b32 s29, s2, 7
  s_add_u32 s28, s28, s29
  s_lshl_b32 s41, s28, 16
  s_lshl_b32 s28, s28, 3
  s_bfe_u32 s29, s2, 0x30003
  s_add_u32 s28, s28, s29
  s_lshl_b32 s29, s29, 4
  s_add_u32 s41, s41, s29
  s_cmp_gt_u32 s28, 320
  s_cbranch_scc1 KM_k2skip
  s_cmp_eq_u32 s28, 320
  s_cselect_b32 s41, 2097152, s41
  s_lshr_b32 s21, s28, 5
  s_lshl_b32 s21, s21, 3
  s_and_b32 s23, s28, 7
  s_add_u32 s21, s21, s23
  s_sub_u32 s23, 128, s21
  s_cmp_eq_u32 s21, 0
  s_cselect_b32 s23, 64, s23
  s_bitcmp1_b32 s28, 3
  s_cselect_b32 s21, s23, s21
  s_mul_i32 s21, s21, 5
  s_bfe_u32 s23, s28, 0x10004
  s_lshl_b32 s23, s23, 7
  s_add_u32 s21, s21, s23
  s_add_u32 s21, s21, 128
  s_sub_u32 s23, s21, 640
  s_min_u32 s21, s21, s23
  s_sub_u32 s23, 640, s21
  s_min_u32 s21, s21, s23
  s_sub_u32 s23, s28, 256
  s_mul_i32 s23, s23, 5
  s_cmp_ge_u32 s28, 256
  s_cselect_b32 s40, s23, s21
  v_and_b32 v1, 15, v0
  v_bfe_u32 v2, v0, 4, 2
  v_bfe_u32 v3, v0, 6, 2
  v_and_b32 v9, 63, v0
  v_lshl_add_u32 v4, v3, 2, v2
  v_xor_b32 v10, v4, v1
  v_lshl_add_u32 v4, v4, 4, v10
  v_lshlrev_b32 v4, 7, v4
  v_lshrrev_b32 v5, 1, v1
  v_and_b32 v6, 1, v1
  v_lshl_add_u32 v5, v6, 3, v5
  v_lshl_add_u32 v5, v2, 4, v5
  v_lshlrev_b32 v5, 4, v5
  v_lshl_add_u32 v5, v3, 11, v5
  s_add_u32 s21, s41, 1048576
  s_add_u32 s23, s21, 32768
  s_lshl_b32 s29, s28, 13
  s_lshl_b32 s48, s26, 14
  s_add_u32 s48, s48, 122880
  v_lshl_add_u32 v6, v3, 4, v1
  v_cvt_f32_u32 v6, v6
  v_cvt_f32_u32 v7, v2
  v_cvt_f32_u32 v8, v1
  v_mul_f32 v7, 4.0, v7
  v_mul_f32 v16, 0xba000000, v6
  v_mul_f32 v10, v7, v16
  v_mul_f32 v11, 0x41500000, v16
  v_cos_f32 v56, v10
  v_sin_f32 v64, v10
  v_add_f32 v10, v10, v16
  v_cos_f32 v57, v10
  v_sin_f32 v65, v10
  v_add_f32 v10, v10, v16
  v_cos_f32 v58, v10
  v_sin_f32 v66, v10
  v_add_f32 v10, v10, v16
  v_cos_f32 v59, v10
  v_sin_f32 v67, v10
  v_add_f32 v10, v10, v11
  v_cos_f32 v60, v10
  v_sin_f32 v68, v10
  v_add_f32 v10, v10, v16
  v_cos_f32 v61, v10
  v_sin_f32 v69, v10
  v_add_f32 v10, v10, v16
  v_cos_f32 v62, v10
  v_sin_f32 v70, v10
  v_add_f32 v10, v10, v16
  v_cos_f32 v63, v10
  v_sin_f32 v71, v10
  s_lshl_b32 s24, s27, 4
  v_cvt_f32_u32 v12, s24
  v_add_f32 v12, v12, v7
  s_mov_b32 s38, 0x35cccccd
  s_cmp_eq_u32 s28, 256
  s_cselect_b32 s38, 0x354ccccd, s38
  s_cmp_eq_u32 s28, 320
  s_cselect_b32 s38, 0x354ccccd, s38
  s_mov_b32 s39, s38
  v_add_f32 v16, 0x00000000, v8
  v_mul_f32 v16, 0x3a000000, v16
  v_mul_f32 v10, v12, v16
  v_cos_f32 v72, v10
  v_sin_f32 v80, v10
  v_add_f32 v10, v10, v16
  v_cos_f32 v73, v10
  v_sin_f32 v81, v10
  v_add_f32 v10, v10, v16
  v_cos_f32 v74, v10
  v_sin_f32 v82, v10
  v_add_f32 v10, v10, v16
  v_cos_f32 v75, v10
  v_sin_f32 v83, v10
  v_add_f32 v16, 0x41800000, v8
  v_mul_f32 v16, 0x3a000000, v16
  v_mul_f32 v10, v12, v16
  v_cos_f32 v76, v10
  v_sin_f32 v84, v10
  v_add_f32 v10, v10, v16
  v_cos_f32 v77, v10
  v_sin_f32 v85, v10
  v_add_f32 v10, v10, v16
  v_cos_f32 v78, v10
  v_sin_f32 v86, v10
  v_add_f32 v10, v10, v16
  v_cos_f32 v79, v10
  v_sin_f32 v87, v10
  v_pk_mul_f32 v[72:73], s[38:39], v[72:73]
  v_pk_mul_f32 v[74:75], s[38:39], v[74:75]
  v_pk_mul_f32 v[76:77], s[38:39], v[76:77]
  v_pk_mul_f32 v[78:79], s[38:39], v[78:79]
  v_pk_mul_f32 v[80:81], s[38:39], v[80:81]
  v_pk_mul_f32 v[82:83], s[38:39], v[82:83]
  v_pk_mul_f32 v[84:85], s[38:39], v[84:85]
  v_pk_mul_f32 v[86:87], s[38:39], v[86:87]
  v_xor_b32 v10, v2, v1
  v_lshlrev_b32 v10, 4, v10
  v_lshl_add_u32 v10, v1, 8, v10
  v_add_u32 v10, s48, v10
  v_xor_b32 v11, 64, v10
  v_xor_b32 v12, 128, v10
  v_xor_b32 v13, 192, v10
  v_lshlrev_b32 v7, 4, v9
  v_add_u32 v7, s48, v7
  s_lshl_b32 s24, s27, 10
  v_add_u32 v6, s24, v7
  v_lshlrev_b32 v8, 4, v9
  v_lshl_add_u32 v8, v3, 11, v8
  s_add_u32 s24, s24, s48
  s_lshl_b32 s25, s40, 13
  s_add_u32 s25, s25, 7340032
  s_mov_b32 m0, s24
  s_mov_b32 s46, 0x8000
  s_waitcnt vmcnt(0)
KM_gx:
  buffer_load_dwordx4 v[24:27], v4, s[12:15], s21 offen sc1
  buffer_load_dwordx4 v[28:31], v4, s[12:15], s23 offen sc1
KM_gx_chk:
  s_waitcnt vmcnt(0)
  v_max3_u32 v32, v24, v25, v26
  v_max3_u32 v33, v28, v29, v30
  v_max3_u32 v32, v32, v27, v31
  v_max_u32 v32, v32, v33
  v_cmp_eq_u32 vcc, -1, v32
  s_nop 1
  s_and_b64 exec, exec, vcc
  s_cbranch_scc0 KM_gx_ok
  s_sleep 2
  s_sub_u32 s46, s46, 1
  s_cmp_lg_u32 s46, 0
  s_cbranch_scc1 KM_gx
KM_gx_ok:
  s_mov_b64 exec, -1
  ds_write_b128 v6, v[24:27]
  ds_write_b128 v6, v[28:31] offset:4096
  s_add_u32 s21, s29, 4194304
  s_add_u32 s23, s21, 1024
  s_waitcnt lgkmcnt(0)
  s_barrier
  buffer_load_dwordx4 v[48:51], v5, s[12:15], s25 offen sc1
  buffer_load_dwordx4 v[52:55], v5, s[12:15], s25 offen offset:1024 sc1
  ds_read_b128 v[16:19], v10 offset:0
  ds_read_b128 v[32:35], v10 offset:4096
  ds_read_b128 v[20:23], v11 offset:0
  ds_read_b128 v[36:39], v11 offset:4096
  ds_read_b128 v[24:27], v12 offset:0
  ds_read_b128 v[40:43], v12 offset:4096
  ds_read_b128 v[28:31], v13 offset:0
  ds_read_b128 v[44:47], v13 offset:4096
  s_and_b32 s24, s28, 0xffffffbf
  s_cmp_lg_u32 s24, 256
  s_cbranch_scc1 KM_k2gen
  s_waitcnt lgkmcnt(0)
  s_cmp_eq_u32 s28, 256
  s_cbranch_scc1 KM_k2z
  v_mov_b32 v16, v18
  v_mov_b32 v17, v19
  v_mov_b32 v20, v22
  v_mov_b32 v21, v23
  v_mov_b32 v24, v26
  v_mov_b32 v25, v27
  v_mov_b32 v28, v30
  v_mov_b32 v29, v31
  v_mov_b32 v32, v34
  v_mov_b32 v33, v35
  v_mov_b32 v36, v38
  v_mov_b32 v37, v39
  v_mov_b32 v40, v42
  v_mov_b32 v41, v43
  v_mov_b32 v44, v46
  v_mov_b32 v45, v47
KM_k2z:
  v_mov_b32 v18, 0
  v_mov_b32 v19, 0
  v_mov_b32 v22, 0
  v_mov_b32 v23, 0
  v_mov_b32 v26, 0
  v_mov_b32 v27, 0
  v_mov_b32 v30, 0
  v_mov_b32 v31, 0
  v_mov_b32 v34, 0
  v_mov_b32 v35, 0
  v_mov_b32 v38, 0
  v_mov_b32 v39, 0
  v_mov_b32 v42, 0
  v_mov_b32 v43, 0
  v_mov_b32 v46, 0
  v_mov_b32 v47, 0
  s_nop 1
KM_k2gen:
  s_waitcnt lgkmcnt(6)
  v_mfma_f32_16x16x32_bf16 v[88:91], v[16:19], v[122:125], 0
  v_mfma_f32_16x16x32_bf16 v[92:95], v[16:19], v[120:123], 0
  v_mfma_f32_16x16x32_bf16 v[96:99], v[32:35], v[122:125], 0
  v_mfma_f32_16x16x32_bf16 v[100:103], v[32:35], v[120:123], 0
  s_waitcnt lgkmcnt(4)
  v_mfma_f32_16x16x32_bf16 v[88:91], v[20:23], v[128:131], v[88:91]
  v_mfma_f32_16x16x32_bf16 v[92:95], v[20:23], v[126:129], v[92:95]
  v_mfma_f32_16x16x32_bf16 v[96:99], v[36:39], v[128:131], v[96:99]
  v_mfma_f32_16x16x32_bf16 v[100:103], v[36:39], v[126:129], v[100:103]
  s_waitcnt lgkmcnt(2)
  v_mfma_f32_16x16x32_bf16 v[88:91], v[24:27], v[134:137], v[88:91]
  v_mfma_f32_16x16x32_bf16 v[92:95], v[24:27], v[132:135], v[92:95]
  v_mfma_f32_16x16x32_bf16 v[96:99], v[40:43], v[134:137], v[96:99]
  v_mfma_f32_16x16x32_bf16 v[100:103], v[40:43], v[132:135], v[100:103]
  s_waitcnt lgkmcnt(0)
  v_mfma_f32_16x16x32_bf16 v[88:91], v[28:31], v[140:143], v[88:91]
  v_mfma_f32_16x16x32_bf16 v[92:95], v[28:31], v[138:141], v[92:95]
  v_mfma_f32_16x16x32_bf16 v[96:99], v[44:47], v[140:143], v[96:99]
  v_mfma_f32_16x16x32_bf16 v[100:103], v[44:47], v[138:141], v[100:103]
  s_nop 5
  v_pk_mul_f32 v[104:105], v[92:93], v[64:65]
  v_pk_mul_f32 v[92:93], v[92:93], v[56:57]
  v_pk_fma_f32 v[92:93], v[88:89], v[64:65], v[92:93]
  v_pk_fma_f32 v[88:89], v[88:89], v[56:57], v[104:105] neg_lo:[0,0,1] neg_hi:[0,0,1]
  v_pk_mul_f32 v[106:107], v[94:95], v[66:67]
  v_pk_mul_f32 v[94:95], v[94:95], v[58:59]
  v_pk_fma_f32 v[94:95], v[90:91], v[66:67], v[94:95]
  v_pk_fma_f32 v[90:91], v[90:91], v[58:59], v[106:107] neg_lo:[0,0,1] neg_hi:[0,0,1]
  v_pk_mul_f32 v[108:109], v[100:101], v[68:69]
  v_pk_mul_f32 v[100:101], v[100:101], v[60:61]
  v_pk_fma_f32 v[100:101], v[96:97], v[68:69], v[100:101]
  v_pk_fma_f32 v[96:97], v[96:97], v[60:61], v[108:109] neg_lo:[0,0,1] neg_hi:[0,0,1]
  v_pk_mul_f32 v[110:111], v[102:103], v[70:71]
  v_pk_mul_f32 v[102:103], v[102:103], v[62:63]
  v_pk_fma_f32 v[102:103], v[98:99], v[70:71], v[102:103]
  v_pk_fma_f32 v[98:99], v[98:99], v[62:63], v[110:111] neg_lo:[0,0,1] neg_hi:[0,0,1]
  v_cvt_pk_bf16_f32 v16, v88, v89
  v_cvt_pk_bf16_f32 v18, v92, v93
  v_cvt_pk_bf16_f32 v17, v90, v91
  v_cvt_pk_bf16_f32 v19, v94, v95
  v_cvt_pk_bf16_f32 v20, v96, v97
  v_cvt_pk_bf16_f32 v22, v100, v101
  v_cvt_pk_bf16_f32 v21, v98, v99
  v_cvt_pk_bf16_f32 v23, v102, v103
  v_mfma_f32_16x16x32_bf16 v[88:91], v[146:149], v[16:19], 0
  v_mfma_f32_16x16x32_bf16 v[92:95], v[144:147], v[16:19], 0
  v_mfma_f32_16x16x32_bf16 v[96:99], v[158:161], v[16:19], 0
  v_mfma_f32_16x16x32_bf16 v[100:103], v[156:159], v[16:19], 0
  v_mfma_f32_16x16x32_bf16 v[88:91], v[152:155], v[20:23], v[88:91]
  v_mfma_f32_16x16x32_bf16 v[92:95], v[150:153], v[20:23], v[92:95]
  v_mfma_f32_16x16x32_bf16 v[96:99], v[164:167], v[20:23], v[96:99]
  v_mfma_f32_16x16x32_bf16 v[100:103], v[162:165], v[20:23], v[100:103]
  s_waitcnt vmcnt(0)
  v_lshlrev_b32 v32, 16, v48
  v_and_b32 v40, 0xffff0000, v48
  v_lshlrev_b32 v33, 16, v49
  v_and_b32 v41, 0xffff0000, v49
  v_lshlrev_b32 v34, 16, v50
  v_and_b32 v42, 0xffff0000, v50
  v_lshlrev_b32 v35, 16, v51
  v_and_b32 v43, 0xffff0000, v51
  v_lshlrev_b32 v36, 16, v52
  v_and_b32 v44, 0xffff0000, v52
  v_lshlrev_b32 v37, 16, v53
  v_and_b32 v45, 0xffff0000, v53
  v_lshlrev_b32 v38, 16, v54
  v_and_b32 v46, 0xffff0000, v54
  v_lshlrev_b32 v39, 16, v55
  v_and_b32 v47, 0xffff0000, v55
  v_pk_mul_f32 v[104:105], v[92:93], v[40:41]
  v_pk_mul_f32 v[92:93], v[92:93], v[32:33]
  v_pk_fma_f32 v[92:93], v[88:89], v[40:41], v[92:93]
  v_pk_fma_f32 v[88:89], v[88:89], v[32:33], v[104:105] neg_lo:[0,0,1] neg_hi:[0,0,1]
  v_pk_mul_f32 v[106:107], v[94:95], v[42:43]
  v_pk_mul_f32 v[94:95], v[94:95], v[34:35]
  v_pk_fma_f32 v[94:95], v[90:91], v[42:43], v[94:95]
  v_pk_fma_f32 v[90:91], v[90:91], v[34:35], v[106:107] neg_lo:[0,0,1] neg_hi:[0,0,1]
  v_pk_mul_f32 v[108:109], v[100:101], v[44:45]
  v_pk_mul_f32 v[100:101], v[100:101], v[36:37]
  v_pk_fma_f32 v[100:101], v[96:97], v[44:45], v[100:101]
  v_pk_fma_f32 v[96:97], v[96:97], v[36:37], v[108:109] neg_lo:[0,0,1] neg_hi:[0,0,1]
  v_pk_mul_f32 v[110:111], v[102:103], v[46:47]
  v_pk_mul_f32 v[102:103], v[102:103], v[38:39]
  v_pk_fma_f32 v[102:103], v[98:99], v[46:47], v[102:103]
  v_pk_fma_f32 v[98:99], v[98:99], v[38:39], v[110:111] neg_lo:[0,0,1] neg_hi:[0,0,1]
  v_cvt_pk_bf16_f32 v26, v88, v89
  v_cvt_pk_bf16_f32 v24, v92, v93
  v_cvt_pk_bf16_f32 v27, v90, v91
  v_cvt_pk_bf16_f32 v25, v94, v95
  v_cvt_pk_bf16_f32 v30, v96, v97
  v_cvt_pk_bf16_f32 v28, v100, v101
  v_cvt_pk_bf16_f32 v31, v98, v99
  v_cvt_pk_bf16_f32 v29, v102, v103
  v_mfma_f32_16x16x32_bf16 v[88:91], v[24:27], v[144:147], 0
  v_mfma_f32_16x16x32_bf16 v[92:95], v[24:27], v[146:149], 0
  v_mfma_f32_16x16x32_bf16 v[96:99], v[24:27], v[156:159], 0
  v_mfma_f32_16x16x32_bf16 v[100:103], v[24:27], v[158:161], 0
  v_mfma_f32_16x16x32_bf16 v[88:91], v[28:31], v[150:153], v[88:91]
  v_mfma_f32_16x16x32_bf16 v[92:95], v[28:31], v[152:155], v[92:95]
  v_mfma_f32_16x16x32_bf16 v[96:99], v[28:31], v[162:165], v[96:99]
  v_mfma_f32_16x16x32_bf16 v[100:103], v[28:31], v[164:167], v[100:103]
  s_nop 5
  v_pk_mul_f32 v[104:105], v[92:93], v[80:81]
  v_pk_mul_f32 v[92:93], v[92:93], v[72:73]
  v_pk_fma_f32 v[92:93], v[88:89], v[80:81], v[92:93]
  v_pk_fma_f32 v[88:89], v[88:89], v[72:73], v[104:105] neg_lo:[0,0,1] neg_hi:[0,0,1]
  v_pk_mul_f32 v[106:107], v[94:95], v[82:83]
  v_pk_mul_f32 v[94:95], v[94:95], v[74:75]
  v_pk_fma_f32 v[94:95], v[90:91], v[82:83], v[94:95]
  v_pk_fma_f32 v[90:91], v[90:91], v[74:75], v[106:107] neg_lo:[0,0,1] neg_hi:[0,0,1]
  v_pk_mul_f32 v[108:109], v[100:101], v[84:85]
  v_pk_mul_f32 v[100:101], v[100:101], v[76:77]
  v_pk_fma_f32 v[100:101], v[96:97], v[84:85], v[100:101]
  v_pk_fma_f32 v[96:97], v[96:97], v[76:77], v[108:109] neg_lo:[0,0,1] neg_hi:[0,0,1]
  v_pk_mul_f32 v[110:111], v[102:103], v[86:87]
  v_pk_mul_f32 v[102:103], v[102:103], v[78:79]
  v_pk_fma_f32 v[102:103], v[98:99], v[86:87], v[102:103]
  v_pk_fma_f32 v[98:99], v[98:99], v[78:79], v[110:111] neg_lo:[0,0,1] neg_hi:[0,0,1]
  v_cvt_pk_bf16_f32 v18, v88, v89
  v_cvt_pk_bf16_f32 v16, v92, v93
  v_cvt_pk_bf16_f32 v19, v90, v91
  v_cvt_pk_bf16_f32 v17, v94, v95
  v_cvt_pk_bf16_f32 v22, v96, v97
  v_cvt_pk_bf16_f32 v20, v100, v101
  v_cvt_pk_bf16_f32 v23, v98, v99
  v_cvt_pk_bf16_f32 v21, v102, v103
  ds_write_b128 v6, v[16:19] offset:8192
  ds_write_b128 v6, v[20:23] offset:12288
  s_waitcnt lgkmcnt(0)
  s_barrier
  ds_read_b128 v[16:19], v7 offset:8192
  ds_read_b128 v[32:35], v7 offset:12288
  ds_read_b128 v[20:23], v7 offset:9216
  ds_read_b128 v[36:39], v7 offset:13312
  ds_read_b128 v[24:27], v7 offset:10240
  ds_read_b128 v[40:43], v7 offset:14336
  ds_read_b128 v[28:31], v7 offset:11264
  ds_read_b128 v[44:47], v7 offset:15360
  s_waitcnt lgkmcnt(6)
  v_mfma_f32_16x16x32_bf16 v[88:91], v[120:123], v[16:19], 0
  v_mfma_f32_16x16x32_bf16 v[92:95], v[122:125], v[16:19], 0
  v_mfma_f32_16x16x32_bf16 v[96:99], v[120:123], v[32:35], 0
  v_mfma_f32_16x16x32_bf16 v[100:103], v[122:125], v[32:35], 0
  s_waitcnt lgkmcnt(4)
  v_mfma_f32_16x16x32_bf16 v[88:91], v[126:129], v[20:23], v[88:91]
  v_mfma_f32_16x16x32_bf16 v[92:95], v[128:131], v[20:23], v[92:95]
  v_mfma_f32_16x16x32_bf16 v[96:99], v[126:129], v[36:39], v[96:99]
  v_mfma_f32_16x16x32_bf16 v[100:103], v[128:131], v[36:39], v[100:103]
  s_waitcnt lgkmcnt(2)
  v_mfma_f32_16x16x32_bf16 v[88:91], v[132:135], v[24:27], v[88:91]
  v_mfma_f32_16x16x32_bf16 v[92:95], v[134:137], v[24:27], v[92:95]
  v_mfma_f32_16x16x32_bf16 v[96:99], v[132:135], v[40:43], v[96:99]
  v_mfma_f32_16x16x32_bf16 v[100:103], v[134:137], v[40:43], v[100:103]
  s_waitcnt lgkmcnt(0)
  v_mfma_f32_16x16x32_bf16 v[88:91], v[138:141], v[28:31], v[88:91]
  v_mfma_f32_16x16x32_bf16 v[92:95], v[140:143], v[28:31], v[92:95]
  v_mfma_f32_16x16x32_bf16 v[96:99], v[138:141], v[44:47], v[96:99]
  v_mfma_f32_16x16x32_bf16 v[100:103], v[140:143], v[44:47], v[100:103]
  s_nop 4
  v_cvt_pk_bf16_f32 v48, v88, v89
  v_cvt_pk_bf16_f32 v49, v90, v91
  v_cvt_pk_bf16_f32 v50, v92, v93
  v_cvt_pk_bf16_f32 v51, v94, v95
  buffer_store_dwordx4 v[48:51], v8, s[12:15], s21 offen sc1
  v_cvt_pk_bf16_f32 v52, v96, v97
  v_cvt_pk_bf16_f32 v53, v98, v99
  v_cvt_pk_bf16_f32 v54, v100, v101
  v_cvt_pk_bf16_f32 v55, v102, v103
  buffer_store_dwordx4 v[52:55], v8, s[12:15], s23 offen sc1
  s_branch KM_k2done
KM_k2skip:
  s_barrier
  s_barrier
KM_k2done:
  v_and_b32 v1, 63, v0
  v_and_b32 v3, 31, v0
  v_lshlrev_b32 v2, 3, v3
  v_bfe_u32 v4, v0, 5, 1
  v_lshl_add_u32 v2, v4, 8, v2
  v_lshlrev_b32 v3, 2, v3
  v_lshl_add_u32 v3, v4, 1, v3
  v_and_b32 v5, 15, v0
  v_bfe_u32 v6, v0, 4, 2
  v_and_b32 v22, 7, v5
  s_lshl_b32 s40, s22, 3
  v_add_u32 v8, s40, v22
  v_cmp_eq_u32 vcc, 0, v8
  s_nop 1
  v_cndmask_b32 v10, 1.0, 0, vcc
  v_cmp_lt_u32 s[42:43], 7, v5
  s_nop 0
  s_and_b64 s[44:45], s[42:43], vcc
  s_andn2_b64 s[42:43], s[42:43], vcc
  v_cndmask_b32 v8, v8, 64, s[44:45]
  v_cndmask_b32 v9, 0, -1, s[42:43]
  v_sub_u32 v22, 128, v8
  v_cndmask_b32 v22, v8, v22, s[42:43]
  v_mul_u32_u24 v22, 5, v22
  v_lshrrev_b32 v23, 1, v6
  v_lshl_add_u32 v22, v23, 7, v22
  v_add_u32 v23, 128, v22
  v_subrev_u32 v24, 640, v23
  v_min_u32 v23, v23, v24
  v_sub_u32 v24, 640, v23
  v_cmp_lt_u32 vcc, v24, v23
  v_min_u32 v23, v23, v24
  v_mov_b32 v24, 0x80008000
  v_cndmask_b32 v12, 0, v24, vcc
  v_and_b32 v25, 1, v6
  v_lshlrev_b32 v25, 4, v25
  v_lshl_add_u32 v11, v23, 13, v25
  v_mul_u32_u24 v23, 40960, v8
  v_add_u32 v13, v23, v25
  s_lshl_b32 s40, s22, 5
  v_lshrrev_b32 v22, 1, v6
  v_lshl_add_u32 v22, v22, 4, v5
  v_add_u32 v22, s40, v22
  v_add_u32 v23, 256, v8
  v_and_b32 v24, 1, v6
  v_lshlrev_b32 v24, 8, v24
  v_lshl_add_u32 v11, v22, 13, v24
  v_lshl_add_u32 v13, v23, 13, v24
  s_and_b32 s23, s3, 15
  s_lshl_b32 s23, s23, 4
  s_lshr_b32 s21, s3, 4
  s_lshl_b32 s21, s21, 10
  s_add_u32 s23, s23, s21
  s_lshr_b32 s21, s20, 1
  s_lshl_b32 s21, s21, 11
  s_add_u32 s23, s23, s21
  s_and_b32 s21, s20, 1
  s_lshl_b32 s21, s21, 9
  s_add_u32 s23, s23, s21
  s_add_u32 s23, s23, 4194304
  s_lshl_b32 s21, s20, 3
  s_add_u32 s21, s21, s22
  s_lshl_b32 s24, s3, 6
  s_add_u32 s24, s24, s21
  s_mul_i32 s24, s24, 1280
  v_cvt_f32_u32 v22, v3
  v_mul_f32 v22, 0x3e4ccccd, v22
  v_add_f32 v23, 0x3e4ccccd, v22
  v_cos_f32 v88, v22
  v_cos_f32 v89, v23
  v_sin_f32 v90, v22
  v_sin_f32 v91, v23
  v_pk_add_f32 v[22:23], v[22:23], v[22:23]
  v_cos_f32 v92, v22
  v_cos_f32 v93, v23
  v_sin_f32 v94, v22
  v_sin_f32 v95, v23
  s_lshl_b32 s27, s22, 4
  v_add_u32 v22, s27, v5
  v_cvt_f32_u32 v22, v22
  v_mul_f32 v22, 0x3c000000, v22
  v_and_b32 v23, 1, v6
  v_cvt_f32_u32 v23, v23
  v_mul_f32 v23, 4.0, v23
  v_lshrrev_b32 v24, 1, v6
  v_cvt_f32_u32 v24, v24
  v_mul_f32 v24, 0x3e800000, v24
  v_fma_f32 v23, v23, v22, v24
  v_mul_f32 v24, 0x40a00000, v22
  v_mul_f32 v27, 0x42800000, v22
  v_cmp_eq_u32 vcc, 2, v6
  s_nop 1
  v_cndmask_b32 v27, v23, v27, vcc
  v_cos_f32 v25, v27
  v_add_f32 v23, v23, v22
  v_cos_f32 v26, v23
  v_add_f32 v23, v23, v22
  v_cvt_pk_bf16_f32 v96, v25, v26
  v_cos_f32 v25, v23
  v_add_f32 v23, v23, v22
  v_cos_f32 v26, v23
  v_add_f32 v23, v23, v24
  v_cvt_pk_bf16_f32 v97, v25, v26
  v_cos_f32 v25, v23
  v_add_f32 v23, v23, v22
  v_cos_f32 v26, v23
  v_add_f32 v23, v23, v22
  v_cvt_pk_bf16_f32 v98, v25, v26
  v_cos_f32 v25, v23
  v_add_f32 v23, v23, v22
  v_cos_f32 v26, v23
  v_add_f32 v23, v23, v24
  v_cvt_pk_bf16_f32 v99, v25, v26
  v_cos_f32 v25, v23
  v_add_f32 v23, v23, v22
  v_cos_f32 v26, v23
  v_add_f32 v23, v23, v22
  v_cvt_pk_bf16_f32 v100, v25, v26
  v_cos_f32 v25, v23
  v_add_f32 v23, v23, v22
  v_cos_f32 v26, v23
  v_add_f32 v23, v23, v24
  v_cvt_pk_bf16_f32 v101, v25, v26
  v_cos_f32 v25, v23
  v_add_f32 v23, v23, v22
  v_cos_f32 v26, v23
  v_add_f32 v23, v23, v22
  v_cvt_pk_bf16_f32 v102, v25, v26
  v_cos_f32 v25, v23
  v_add_f32 v23, v23, v22
  v_cos_f32 v26, v23
  v_add_f32 v23, v23, v24
  v_cvt_pk_bf16_f32 v103, v25, v26
  v_cos_f32 v25, v23
  v_add_f32 v23, v23, v22
  v_cos_f32 v26, v23
  v_add_f32 v23, v23, v22
  v_cvt_pk_bf16_f32 v104, v25, v26
  v_cos_f32 v25, v23
  v_add_f32 v23, v23, v22
  v_cos_f32 v26, v23
  v_add_f32 v23, v23, v24
  v_cvt_pk_bf16_f32 v105, v25, v26
  v_cos_f32 v25, v23
  v_add_f32 v23, v23, v22
  v_cos_f32 v26, v23
  v_add_f32 v23, v23, v22
  v_cvt_pk_bf16_f32 v106, v25, v26
  v_cos_f32 v25, v23
  v_add_f32 v23, v23, v22
  v_cos_f32 v26, v23
  v_add_f32 v23, v23, v24
  v_cvt_pk_bf16_f32 v107, v25, v26
  v_cos_f32 v25, v23
  v_add_f32 v23, v23, v22
  v_cos_f32 v26, v23
  v_add_f32 v23, v23, v22
  v_cvt_pk_bf16_f32 v108, v25, v26
  v_cos_f32 v25, v23
  v_add_f32 v23, v23, v22
  v_cos_f32 v26, v23
  v_add_f32 v23, v23, v24
  v_cvt_pk_bf16_f32 v109, v25, v26
  v_cos_f32 v25, v23
  v_add_f32 v23, v23, v22
  v_cos_f32 v26, v23
  v_add_f32 v23, v23, v22
  v_cvt_pk_bf16_f32 v110, v25, v26
  v_cos_f32 v25, v23
  v_add_f32 v23, v23, v22
  v_cos_f32 v26, v23
  v_add_f32 v23, v23, v24
  v_cvt_pk_bf16_f32 v111, v25, v26
  v_lshlrev_b32 v14, 5, v5
  v_lshl_add_u32 v14, v6, 3, v14
  s_lshl_b32 s27, s22, 9
  s_add_u32 s27, s27, 98304
  v_add_u32 v14, s27, v14
  v_and_b32 v15, 4096, v9
  v_add_u32 v15, v15, v14
  v_xor_b32 v112, 4096, v15
  v_lshlrev_b32 v113, 3, v1
  v_add_u32 v113, 98304, v113
  v_and_b32 v22, 7, v5
  v_mul_u32_u24 v22, 528, v22
  v_lshl_add_u32 v22, v6, 4, v22
  s_lshl_b32 s27, s22, 6
  s_add_u32 s27, s27, 110592
  v_add_u32 v17, s27, v22
  v_lshrrev_b32 v22, 3, v5
  v_mul_u32_u24 v22, 8448, v22
  v_add_u32 v16, v17, v22
  v_lshlrev_b32 v4, 2, v3
  s_mul_i32 s27, s22, 528
  s_add_u32 s27, s27, 110592
  v_add_u32 v7, s27, v4
  v_add_u32 v4, 155648, v4
  v_and_b32 v22, 0x80000000, v9
  v_xor_b32 v22, v22, v10
  v_and_b32 v23, 0x80008000, v9
  v_xor_b32 v24, v23, v12
  ds_read_b64 v[120:121], v4 offset:0
  ds_read_b64 v[140:141], v4 offset:5120
  ds_read_b64 v[130:131], v4 offset:2560
  ds_read_b64 v[122:123], v4 offset:512
  ds_read_b64 v[142:143], v4 offset:5632
  ds_read_b64 v[132:133], v4 offset:3072
  ds_read_b64 v[124:125], v4 offset:1024
  ds_read_b64 v[144:145], v4 offset:6144
  ds_read_b64 v[134:135], v4 offset:3584
  ds_read_b64 v[126:127], v4 offset:1536
  ds_read_b64 v[146:147], v4 offset:6656
  ds_read_b64 v[136:137], v4 offset:4096
  ds_read_b64 v[128:129], v4 offset:2048
  ds_read_b64 v[148:149], v4 offset:7168
  ds_read_b64 v[138:139], v4 offset:4608
  s_waitcnt lgkmcnt(0)
  s_mov_b32 s46, 0x8000
  s_waitcnt vmcnt(0)
KM_gy:
  buffer_load_dwordx4 v[28:31], v11, s[12:15], s23 offen sc1
  buffer_load_dwordx4 v[32:35], v13, s[12:15], s23 offen sc1
KM_gy_chk:
  s_waitcnt vmcnt(0)
  v_max3_u32 v36, v28, v29, v30
  v_max3_u32 v37, v32, v33, v34
  v_max3_u32 v36, v36, v31, v35
  v_max_u32 v36, v36, v37
  v_cmp_eq_u32 vcc, -1, v36
  s_nop 1
  s_and_b64 exec, exec, vcc
  s_cbranch_scc0 KM_gy_ok
  s_sleep 2
  s_sub_u32 s46, s46, 1
  s_cmp_lg_u32 s46, 0
  s_cbranch_scc1 KM_gy
KM_gy_ok:
  s_mov_b64 exec, -1
  v_cndmask_b32 v32, v32, v34, s[42:43]
  v_cndmask_b32 v33, v33, v35, s[42:43]
  v_xor_b32 v26, v30, v24
  v_xor_b32 v27, v31, v24
  v_xor_b32 v30, v30, v12
  v_xor_b32 v31, v31, v12
  ds_write_b64 v14, v[32:33] offset:8192
  v_lshlrev_b32 v36, 16, v28
  v_and_b32 v37, 0xffff0000, v28
  v_lshlrev_b32 v40, 16, v30
  v_and_b32 v41, 0xffff0000, v30
  v_lshlrev_b32 v44, 16, v28
  v_and_b32 v45, 0xffff0000, v28
  v_lshlrev_b32 v48, 16, v26
  v_and_b32 v49, 0xffff0000, v26
  v_lshlrev_b32 v38, 16, v29
  v_and_b32 v39, 0xffff0000, v29
  v_lshlrev_b32 v42, 16, v31
  v_and_b32 v43, 0xffff0000, v31
  v_lshlrev_b32 v46, 16, v29
  v_and_b32 v47, 0xffff0000, v29
  v_lshlrev_b32 v50, 16, v27
  v_and_b32 v51, 0xffff0000, v27
  v_fmac_f32_dpp v44, v36, v22 row_ror:8 row_mask:0xf bank_mask:0xf
  v_fmac_f32_dpp v48, v40, v10 row_ror:8 row_mask:0xf bank_mask:0xf
  v_fmac_f32_dpp v45, v37, v22 row_ror:8 row_mask:0xf bank_mask:0xf
  v_fmac_f32_dpp v49, v41, v10 row_ror:8 row_mask:0xf bank_mask:0xf
  v_fmac_f32_dpp v46, v38, v22 row_ror:8 row_mask:0xf bank_mask:0xf
  v_fmac_f32_dpp v50, v42, v10 row_ror:8 row_mask:0xf bank_mask:0xf
  v_fmac_f32_dpp v47, v39, v22 row_ror:8 row_mask:0xf bank_mask:0xf
  v_fmac_f32_dpp v51, v43, v10 row_ror:8 row_mask:0xf bank_mask:0xf
  v_cvt_pk_bf16_f32 v52, v44, v45
  v_cvt_pk_bf16_f32 v53, v46, v47
  v_cvt_pk_bf16_f32 v54, v48, v49
  v_cvt_pk_bf16_f32 v55, v50, v51
  ds_write_b64 v15, v[52:53]
  ds_write_b64 v112, v[54:55]
  s_waitcnt lgkmcnt(0)
  s_barrier
  ds_read_b64_tr_b16 v[28:29], v113 offset:0
  ds_read_b64_tr_b16 v[30:31], v113 offset:512
  ds_read_b64_tr_b16 v[32:33], v113 offset:1024
  ds_read_b64_tr_b16 v[34:35], v113 offset:1536
  ds_read_b64_tr_b16 v[36:37], v113 offset:2048
  ds_read_b64_tr_b16 v[38:39], v113 offset:2560
  ds_read_b64_tr_b16 v[40:41], v113 offset:3072
  ds_read_b64_tr_b16 v[42:43], v113 offset:3584
  ds_read_b64_tr_b16 v[44:45], v113 offset:4096
  ds_read_b64_tr_b16 v[46:47], v113 offset:4608
  ds_read_b64_tr_b16 v[48:49], v113 offset:5120
  ds_read_b64_tr_b16 v[50:51], v113 offset:5632
  ds_read_b64_tr_b16 v[52:53], v113 offset:6144
  ds_read_b64_tr_b16 v[54:55], v113 offset:6656
  ds_read_b64_tr_b16 v[56:57], v113 offset:7168
  ds_read_b64_tr_b16 v[58:59], v113 offset:7680
  s_waitcnt lgkmcnt(8)
  v_mfma_f32_16x16x32_bf16 v[76:79], v[96:99], v[28:31], 0
  v_mfma_f32_16x16x32_bf16 v[76:79], v[100:103], v[32:35], v[76:79]
  v_mfma_f32_16x16x32_bf16 v[76:79], v[104:107], v[36:39], v[76:79]
  v_mfma_f32_16x16x32_bf16 v[76:79], v[108:111], v[40:43], v[76:79]
  ds_read_b64_tr_b16 v[60:61], v113 offset:8192
  ds_read_b64_tr_b16 v[62:63], v113 offset:8704
  ds_read_b64_tr_b16 v[64:65], v113 offset:9216
  ds_read_b64_tr_b16 v[66:67], v113 offset:9728
  ds_read_b64_tr_b16 v[68:69], v113 offset:10240
  ds_read_b64_tr_b16 v[70:71], v113 offset:10752
  ds_read_b64_tr_b16 v[72:73], v113 offset:11264
  ds_read_b64_tr_b16 v[74:75], v113 offset:11776
  s_waitcnt lgkmcnt(8)
  v_mfma_f32_16x16x32_bf16 v[80:83], v[96:99], v[44:47], 0
  v_mfma_f32_16x16x32_bf16 v[80:83], v[100:103], v[48:51], v[80:83]
  v_mfma_f32_16x16x32_bf16 v[80:83], v[104:107], v[52:55], v[80:83]
  v_mfma_f32_16x16x32_bf16 v[80:83], v[108:111], v[56:59], v[80:83]
  s_waitcnt lgkmcnt(0)
  v_mfma_f32_16x16x32_bf16 v[84:87], v[96:99], v[60:63], 0
  v_mfma_f32_16x16x32_bf16 v[84:87], v[100:103], v[64:67], v[84:87]
  v_mfma_f32_16x16x32_bf16 v[84:87], v[104:107], v[68:71], v[84:87]
  v_mfma_f32_16x16x32_bf16 v[84:87], v[108:111], v[72:75], v[84:87]
  ds_write_b128 v16, v[76:79] offset:4224
  v_lshlrev_b32 v28, 16, v114
  v_and_b32 v29, 0xffff0000, v114
  v_lshlrev_b32 v30, 16, v115
  v_and_b32 v31, 0xffff0000, v115
  v_lshlrev_b32 v32, 16, v116
  v_and_b32 v33, 0xffff0000, v116
  v_lshlrev_b32 v34, 16, v117
  v_and_b32 v35, 0xffff0000, v117
  v_lshlrev_b32 v36, 16, v118
  v_and_b32 v37, 0xffff0000, v118
  ds_write_b128 v16, v[80:83] offset:8448
  ds_write_b128 v17, v[84:87]
  s_waitcnt lgkmcnt(0)
  s_barrier
  ds_read_b64 v[40:41], v7 offset:0
  ds_read_b64 v[42:43], v7 offset:4224
  ds_read_b64 v[44:45], v7 offset:8448
  ds_read_b64 v[46:47], v7 offset:12672
  ds_read_b64 v[48:49], v7 offset:16896
  s_waitcnt lgkmcnt(0)
  s_barrier
  v_pk_mul_f32 v[50:51], v[42:43], v[88:89]
  v_pk_mul_f32 v[52:53], v[42:43], v[90:91]
  v_pk_fma_f32 v[50:51], v[44:45], v[90:91], v[50:51] neg_lo:[1,0,0] neg_hi:[1,0,0]
  v_pk_fma_f32 v[52:53], v[44:45], v[88:89], v[52:53]
  v_pk_mul_f32 v[54:55], v[46:47], v[92:93]
  v_pk_mul_f32 v[56:57], v[46:47], v[94:95]
  v_pk_fma_f32 v[54:55], v[48:49], v[94:95], v[54:55] neg_lo:[1,0,0] neg_hi:[1,0,0]
  v_pk_fma_f32 v[56:57], v[48:49], v[92:93], v[56:57]
  v_pk_add_f32 v[66:67], v[40:41], v[50:51]
  v_pk_fma_f32 v[58:59], s[30:31], v[50:51], v[40:41]
  v_pk_fma_f32 v[60:61], s[32:33], v[50:51], v[40:41]
  v_pk_mul_f32 v[62:63], s[34:35], v[52:53]
  v_pk_mul_f32 v[64:65], s[36:37], v[52:53]
  v_pk_add_f32 v[66:67], v[66:67], v[54:55]
  v_pk_fma_f32 v[58:59], s[32:33], v[54:55], v[58:59]
  v_pk_fma_f32 v[60:61], s[30:31], v[54:55], v[60:61]
  v_pk_fma_f32 v[62:63], s[36:37], v[56:57], v[62:63]
  v_pk_fma_f32 v[64:65], s[34:35], v[56:57], v[64:65] neg_lo:[0,1,0] neg_hi:[0,1,0]
  v_pk_fma_f32 v[28:29], v[120:121], v[66:67], v[28:29]
  v_pk_add_f32 v[68:69], v[58:59], v[62:63] neg_lo:[0,1] neg_hi:[0,1]
  v_pk_add_f32 v[70:71], v[58:59], v[62:63]
  v_pk_add_f32 v[72:73], v[60:61], v[64:65] neg_lo:[0,1] neg_hi:[0,1]
  v_pk_add_f32 v[74:75], v[60:61], v[64:65]
  v_pk_fma_f32 v[32:33], v[124:125], v[68:69], v[32:33]
  v_pk_fma_f32 v[34:35], v[126:127], v[70:71], v[34:35]
  v_pk_fma_f32 v[36:37], v[128:129], v[72:73], v[36:37]
  v_pk_fma_f32 v[30:31], v[122:123], v[74:75], v[30:31]
  s_add_u32 s25, s24, 10485760
  s_add_u32 s26, s24, 13631488
  v_cvt_pk_bf16_f32 v16, v28, v29
  v_cvt_pk_bf16_f32 v17, v30, v31
  v_cvt_pk_bf16_f32 v18, v32, v33
  v_cvt_pk_bf16_f32 v19, v34, v35
  v_cvt_pk_bf16_f32 v20, v36, v37
  v_permlane32_swap_b32 v16, v17
  v_permlane32_swap_b32 v18, v19
  buffer_store_dwordx2 v[16:17], v2, s[12:15], s25 offen sc1
  buffer_store_dwordx2 v[18:19], v2, s[12:15], s25 offen offset:512 sc1
  v_pk_add_f32 v[22:23], v[28:29], v[30:31]
  v_pk_add_f32 v[24:25], v[32:33], v[34:35]
  v_pk_add_f32 v[22:23], v[22:23], v[36:37]
  v_pk_add_f32 v[22:23], v[22:23], v[24:25]
  v_add_f32 v22, v22, v23
  s_nop 1
  v_add_f32_dpp v22, v22, v22 quad_perm:[1,0,3,2] row_mask:0xf bank_mask:0xf
  s_nop 1
  v_add_f32_dpp v22, v22, v22 quad_perm:[2,3,0,1] row_mask:0xf bank_mask:0xf
  s_nop 1
  v_add_f32_dpp v22, v22, v22 row_ror:4 row_mask:0xf bank_mask:0xf
  s_nop 1
  v_add_f32_dpp v22, v22, v22 row_ror:8 row_mask:0xf bank_mask:0xf
  v_mov_b32 v23, v22
  s_nop 1
  v_permlane16_swap_b32 v22, v23
  v_add_f32 v22, v22, v23
  v_mov_b32 v23, v22
  s_nop 1
  v_permlane32_swap_b32 v22, v23
  v_add_f32 v22, v22, v23
  v_mul_f32 v22, 0xbacccccd, v22
  v_pk_add_f32 v[28:29], v[28:29], v[22:23] op_sel_hi:[1,0]
  v_pk_add_f32 v[30:31], v[30:31], v[22:23] op_sel_hi:[1,0]
  v_pk_add_f32 v[32:33], v[32:33], v[22:23] op_sel_hi:[1,0]
  v_pk_add_f32 v[34:35], v[34:35], v[22:23] op_sel_hi:[1,0]
  v_pk_add_f32 v[36:37], v[36:37], v[22:23] op_sel_hi:[1,0]
  v_pk_mul_f32 v[22:23], v[28:29], v[28:29]
  v_pk_mul_f32 v[24:25], v[30:31], v[30:31]
  v_pk_fma_f32 v[22:23], v[32:33], v[32:33], v[22:23]
  v_pk_fma_f32 v[24:25], v[34:35], v[34:35], v[24:25]
  v_pk_fma_f32 v[22:23], v[36:37], v[36:37], v[22:23]
  v_pk_add_f32 v[22:23], v[22:23], v[24:25]
  v_add_f32 v22, v22, v23
  s_nop 1
  v_add_f32_dpp v22, v22, v22 quad_perm:[1,0,3,2] row_mask:0xf bank_mask:0xf
  s_nop 1
  v_add_f32_dpp v22, v22, v22 quad_perm:[2,3,0,1] row_mask:0xf bank_mask:0xf
  s_nop 1
  v_add_f32_dpp v22, v22, v22 row_ror:4 row_mask:0xf bank_mask:0xf
  s_nop 1
  v_add_f32_dpp v22, v22, v22 row_ror:8 row_mask:0xf bank_mask:0xf
  v_mov_b32 v23, v22
  s_nop 1
  v_permlane16_swap_b32 v22, v23
  v_add_f32 v22, v22, v23
  v_mov_b32 v23, v22
  s_nop 1
  v_permlane32_swap_b32 v22, v23
  v_add_f32 v22, v22, v23
  v_mov_b32 v23, 0x3727c5ac
  v_fmac_f32 v23, 0x3acccccd, v22
  v_rsq_f32 v22, v23
  v_bfe_u32 v24, v0, 5, 1
  v_mul_u32_u24 v24, 3145472, v24
  v_add_u32 v24, v24, v2
  v_pk_mul_f32 v[140:141], v[140:141], v[22:23] op_sel_hi:[1,0]
  v_pk_mul_f32 v[142:143], v[142:143], v[22:23] op_sel_hi:[1,0]
  v_pk_mul_f32 v[144:145], v[144:145], v[22:23] op_sel_hi:[1,0]
  v_pk_mul_f32 v[146:147], v[146:147], v[22:23] op_sel_hi:[1,0]
  v_pk_mul_f32 v[148:149], v[148:149], v[22:23] op_sel_hi:[1,0]
  v_pk_fma_f32 v[28:29], v[28:29], v[140:141], v[130:131]
  v_pk_fma_f32 v[30:31], v[30:31], v[142:143], v[132:133]
  v_pk_fma_f32 v[32:33], v[32:33], v[144:145], v[134:135]
  v_pk_fma_f32 v[34:35], v[34:35], v[146:147], v[136:137]
  v_pk_fma_f32 v[36:37], v[36:37], v[148:149], v[138:139]
  v_cvt_pk_bf16_f32 v40, v28, v29
  v_cvt_pk_bf16_f32 v41, v30, v31
  v_cvt_pk_bf16_f32 v42, v32, v33
  v_cvt_pk_bf16_f32 v43, v34, v35
  v_cvt_pk_bf16_f32 v21, v36, v37
  v_permlane32_swap_b32 v40, v41
  v_permlane32_swap_b32 v42, v43
  v_permlane32_swap_b32 v20, v21
  buffer_store_dwordx2 v[40:41], v2, s[12:15], s26 offen sc1
  buffer_store_dwordx2 v[42:43], v2, s[12:15], s26 offen offset:512 sc1
  buffer_store_dwordx2 v[20:21], v24, s[12:15], s25 offen offset:1024 sc1
  v_mov_b32 v2, v1
  s_lshr_b32 s26, s22, 2
  s_and_b32 s27, s22, 3
  v_lshrrev_b32 v3, 4, v2
  v_bfe_u32 v4, v2, 2, 2
  v_lshl_add_u32 v4, v3, 3, v4
  v_mul_u32_u24 v4, 192, v4
  v_and_b32 v5, 3, v2
  v_lshl_add_u32 v4, v5, 3, v4
  v_and_b32 v5, 1, v3
  v_lshlrev_b32 v5, 5, v5
  s_mul_i32 s28, s26, 96
  v_add_u32 v4, s28, v4
  s_cmp_eq_u32 s26, 0
  s_cselect_b32 s29, 1, -1
  v_mul_lo_u32 v5, v5, s29
  v_add_u32 v6, v4, v5
  v_sub_u32 v7, v4, v5
  v_add_u32 v8, 49152, v6
  v_add_u32 v9, 49152, v7
  v_and_b32 v10, 15, v2
  v_lshrrev_b32 v11, 1, v10
  v_xor_b32 v11, v11, v3
  v_lshlrev_b32 v11, 4, v11
  v_lshl_add_u32 v11, v10, 7, v11
  s_lshl_b32 s28, s27, 12
  s_add_u32 s28, s28, 98304
  v_add_u32 v11, s28, v11
  v_xor_b32 v12, 64, v11
  s_load_dwordx2 s[60:61], s[0:1], 72
  s_waitcnt vmcnt(0)
  s_barrier
  s_barrier
  ds_read_b128 v[88:91], v11 offset:0
  ds_read_b128 v[92:95], v11 offset:2048
  ds_read_b64_tr_b16 v[64:65], v6 offset:0
  ds_read_b64_tr_b16 v[66:67], v6 offset:768
  ds_read_b64_tr_b16 v[68:69], v7 offset:32
  ds_read_b64_tr_b16 v[70:71], v7 offset:800
  ds_read_b64_tr_b16 v[72:73], v6 offset:64
  ds_read_b64_tr_b16 v[74:75], v6 offset:832
  ds_read_b64_tr_b16 v[76:77], v6 offset:6144
  ds_read_b64_tr_b16 v[78:79], v6 offset:6912
  ds_read_b64_tr_b16 v[80:81], v7 offset:6176
  ds_read_b64_tr_b16 v[82:83], v7 offset:6944
  ds_read_b64_tr_b16 v[84:85], v6 offset:6208
  ds_read_b64_tr_b16 v[86:87], v6 offset:6976
  s_waitcnt lgkmcnt(0)
  v_mfma_f32_16x16x32_bf16 v[16:19], v[64:67], v[88:91], 0
  ds_read_b128 v[120:123], v12 offset:0
  ds_read_b128 v[124:127], v12 offset:2048
  v_mfma_f32_16x16x32_bf16 v[40:43], v[64:67], v[92:95], 0
  ds_read_b64_tr_b16 v[96:97], v6 offset:12288
  ds_read_b64_tr_b16 v[98:99], v6 offset:13056
  v_mfma_f32_16x16x32_bf16 v[20:23], v[68:71], v[88:91], 0
  ds_read_b64_tr_b16 v[100:101], v7 offset:12320
  ds_read_b64_tr_b16 v[102:103], v7 offset:13088
  v_mfma_f32_16x16x32_bf16 v[44:47], v[68:71], v[92:95], 0
  ds_read_b64_tr_b16 v[104:105], v6 offset:12352
  ds_read_b64_tr_b16 v[106:107], v6 offset:13120
  v_mfma_f32_16x16x32_bf16 v[24:27], v[72:75], v[88:91], 0
  ds_read_b64_tr_b16 v[108:109], v6 offset:18432
  ds_read_b64_tr_b16 v[110:111], v6 offset:19200
  v_mfma_f32_16x16x32_bf16 v[48:51], v[72:75], v[92:95], 0
  ds_read_b64_tr_b16 v[112:113], v7 offset:18464
  ds_read_b64_tr_b16 v[114:115], v7 offset:19232
  v_mfma_f32_16x16x32_bf16 v[28:31], v[76:79], v[88:91], 0
  ds_read_b64_tr_b16 v[116:117], v6 offset:18496
  ds_read_b64_tr_b16 v[118:119], v6 offset:19264
  v_mfma_f32_16x16x32_bf16 v[52:55], v[76:79], v[92:95], 0
  v_mfma_f32_16x16x32_bf16 v[32:35], v[80:83], v[88:91], 0
  v_mfma_f32_16x16x32_bf16 v[56:59], v[80:83], v[92:95], 0
  v_mfma_f32_16x16x32_bf16 v[36:39], v[84:87], v[88:91], 0
  v_mfma_f32_16x16x32_bf16 v[60:63], v[84:87], v[92:95], 0
  s_waitcnt lgkmcnt(0)
  s_barrier
  v_mfma_f32_16x16x32_bf16 v[16:19], v[96:99], v[120:123], v[16:19]
  ds_read_b128 v[88:91], v11 offset:16384
  ds_read_b128 v[92:95], v11 offset:18432
  v_mfma_f32_16x16x32_bf16 v[40:43], v[96:99], v[124:127], v[40:43]
  ds_read_b64_tr_b16 v[64:65], v6 offset:24576
  ds_read_b64_tr_b16 v[66:67], v6 offset:25344
  v_mfma_f32_16x16x32_bf16 v[20:23], v[100:103], v[120:123], v[20:23]
  ds_read_b64_tr_b16 v[68:69], v7 offset:24608
  ds_read_b64_tr_b16 v[70:71], v7 offset:25376
  v_mfma_f32_16x16x32_bf16 v[44:47], v[100:103], v[124:127], v[44:47]
  ds_read_b64_tr_b16 v[72:73], v6 offset:24640
  ds_read_b64_tr_b16 v[74:75], v6 offset:25408
  v_mfma_f32_16x16x32_bf16 v[24:27], v[104:107], v[120:123], v[24:27]
  ds_read_b64_tr_b16 v[76:77], v6 offset:30720
  ds_read_b64_tr_b16 v[78:79], v6 offset:31488
  v_mfma_f32_16x16x32_bf16 v[48:51], v[104:107], v[124:127], v[48:51]
  ds_read_b64_tr_b16 v[80:81], v7 offset:30752
  ds_read_b64_tr_b16 v[82:83], v7 offset:31520
  v_mfma_f32_16x16x32_bf16 v[28:31], v[108:111], v[120:123], v[28:31]
  ds_read_b64_tr_b16 v[84:85], v6 offset:30784
  ds_read_b64_tr_b16 v[86:87], v6 offset:31552
  v_mfma_f32_16x16x32_bf16 v[52:55], v[108:111], v[124:127], v[52:55]
  v_mfma_f32_16x16x32_bf16 v[32:35], v[112:115], v[120:123], v[32:35]
  v_mfma_f32_16x16x32_bf16 v[56:59], v[112:115], v[124:127], v[56:59]
  v_mfma_f32_16x16x32_bf16 v[36:39], v[116:119], v[120:123], v[36:39]
  v_mfma_f32_16x16x32_bf16 v[60:63], v[116:119], v[124:127], v[60:63]
  s_waitcnt lgkmcnt(0)
  v_mfma_f32_16x16x32_bf16 v[16:19], v[64:67], v[88:91], v[16:19]
  ds_read_b128 v[120:123], v12 offset:16384
  ds_read_b128 v[124:127], v12 offset:18432
  v_mfma_f32_16x16x32_bf16 v[40:43], v[64:67], v[92:95], v[40:43]
  ds_read_b64_tr_b16 v[96:97], v6 offset:36864
  ds_read_b64_tr_b16 v[98:99], v6 offset:37632
  v_mfma_f32_16x16x32_bf16 v[20:23], v[68:71], v[88:91], v[20:23]
  ds_read_b64_tr_b16 v[100:101], v7 offset:36896
  ds_read_b64_tr_b16 v[102:103], v7 offset:37664
  v_mfma_f32_16x16x32_bf16 v[44:47], v[68:71], v[92:95], v[44:47]
  ds_read_b64_tr_b16 v[104:105], v6 offset:36928
  ds_read_b64_tr_b16 v[106:107], v6 offset:37696
  v_mfma_f32_16x16x32_bf16 v[24:27], v[72:75], v[88:91], v[24:27]
  ds_read_b64_tr_b16 v[108:109], v6 offset:43008
  ds_read_b64_tr_b16 v[110:111], v6 offset:43776
  v_mfma_f32_16x16x32_bf16 v[48:51], v[72:75], v[92:95], v[48:51]
  ds_read_b64_tr_b16 v[112:113], v7 offset:43040
  ds_read_b64_tr_b16 v[114:115], v7 offset:43808
  v_mfma_f32_16x16x32_bf16 v[28:31], v[76:79], v[88:91], v[28:31]
  ds_read_b64_tr_b16 v[116:117], v6 offset:43072
  ds_read_b64_tr_b16 v[118:119], v6 offset:43840
  v_mfma_f32_16x16x32_bf16 v[52:55], v[76:79], v[92:95], v[52:55]
  v_mfma_f32_16x16x32_bf16 v[32:35], v[80:83], v[88:91], v[32:35]
  v_mfma_f32_16x16x32_bf16 v[56:59], v[80:83], v[92:95], v[56:59]
  v_mfma_f32_16x16x32_bf16 v[36:39], v[84:87], v[88:91], v[36:39]
  v_mfma_f32_16x16x32_bf16 v[60:63], v[84:87], v[92:95], v[60:63]
  s_waitcnt lgkmcnt(0)
  s_barrier
  v_mfma_f32_16x16x32_bf16 v[16:19], v[96:99], v[120:123], v[16:19]
  ds_read_b128 v[88:91], v11 offset:32768
  ds_read_b128 v[92:95], v11 offset:34816
  v_mfma_f32_16x16x32_bf16 v[40:43], v[96:99], v[124:127], v[40:43]
  ds_read_b64_tr_b16 v[64:65], v8 offset:0
  ds_read_b64_tr_b16 v[66:67], v8 offset:768
  v_mfma_f32_16x16x32_bf16 v[20:23], v[100:103], v[120:123], v[20:23]
  ds_read_b64_tr_b16 v[68:69], v9 offset:32
  ds_read_b64_tr_b16 v[70:71], v9 offset:800
  v_mfma_f32_16x16x32_bf16 v[44:47], v[100:103], v[124:127], v[44:47]
  ds_read_b64_tr_b16 v[72:73], v8 offset:64
  ds_read_b64_tr_b16 v[74:75], v8 offset:832
  v_mfma_f32_16x16x32_bf16 v[24:27], v[104:107], v[120:123], v[24:27]
  ds_read_b64_tr_b16 v[76:77], v8 offset:6144
  ds_read_b64_tr_b16 v[78:79], v8 offset:6912
  v_mfma_f32_16x16x32_bf16 v[48:51], v[104:107], v[124:127], v[48:51]
  ds_read_b64_tr_b16 v[80:81], v9 offset:6176
  ds_read_b64_tr_b16 v[82:83], v9 offset:6944
  v_mfma_f32_16x16x32_bf16 v[28:31], v[108:111], v[120:123], v[28:31]
  ds_read_b64_tr_b16 v[84:85], v8 offset:6208
  ds_read_b64_tr_b16 v[86:87], v8 offset:6976
  v_mfma_f32_16x16x32_bf16 v[52:55], v[108:111], v[124:127], v[52:55]
  v_mfma_f32_16x16x32_bf16 v[32:35], v[112:115], v[120:123], v[32:35]
  v_mfma_f32_16x16x32_bf16 v[56:59], v[112:115], v[124:127], v[56:59]
  v_mfma_f32_16x16x32_bf16 v[36:39], v[116:119], v[120:123], v[36:39]
  v_mfma_f32_16x16x32_bf16 v[60:63], v[116:119], v[124:127], v[60:63]
  s_waitcnt lgkmcnt(0)
  v_mfma_f32_16x16x32_bf16 v[16:19], v[64:67], v[88:91], v[16:19]
  ds_read_b128 v[120:123], v12 offset:32768
  ds_read_b128 v[124:127], v12 offset:34816
  v_mfma_f32_16x16x32_bf16 v[40:43], v[64:67], v[92:95], v[40:43]
  ds_read_b64_tr_b16 v[96:97], v8 offset:12288
  ds_read_b64_tr_b16 v[98:99], v8 offset:13056
  v_mfma_f32_16x16x32_bf16 v[20:23], v[68:71], v[88:91], v[20:23]
  ds_read_b64_tr_b16 v[100:101], v9 offset:12320
  ds_read_b64_tr_b16 v[102:103], v9 offset:13088
  v_mfma_f32_16x16x32_bf16 v[44:47], v[68:71], v[92:95], v[44:47]
  ds_read_b64_tr_b16 v[104:105], v8 offset:12352
  ds_read_b64_tr_b16 v[106:107], v8 offset:13120
  v_mfma_f32_16x16x32_bf16 v[24:27], v[72:75], v[88:91], v[24:27]
  ds_read_b64_tr_b16 v[108:109], v8 offset:18432
  ds_read_b64_tr_b16 v[110:111], v8 offset:19200
  v_mfma_f32_16x16x32_bf16 v[48:51], v[72:75], v[92:95], v[48:51]
  ds_read_b64_tr_b16 v[112:113], v9 offset:18464
  ds_read_b64_tr_b16 v[114:115], v9 offset:19232
  v_mfma_f32_16x16x32_bf16 v[28:31], v[76:79], v[88:91], v[28:31]
  ds_read_b64_tr_b16 v[116:117], v8 offset:18496
  ds_read_b64_tr_b16 v[118:119], v8 offset:19264
  v_mfma_f32_16x16x32_bf16 v[52:55], v[76:79], v[92:95], v[52:55]
  v_mfma_f32_16x16x32_bf16 v[32:35], v[80:83], v[88:91], v[32:35]
  v_mfma_f32_16x16x32_bf16 v[56:59], v[80:83], v[92:95], v[56:59]
  v_mfma_f32_16x16x32_bf16 v[36:39], v[84:87], v[88:91], v[36:39]
  v_mfma_f32_16x16x32_bf16 v[60:63], v[84:87], v[92:95], v[60:63]
  s_waitcnt lgkmcnt(0)
  s_barrier
  v_mfma_f32_16x16x32_bf16 v[16:19], v[96:99], v[120:123], v[16:19]
  ds_read_b128 v[88:91], v11 offset:49152
  ds_read_b128 v[92:95], v11 offset:51200
  v_mfma_f32_16x16x32_bf16 v[40:43], v[96:99], v[124:127], v[40:43]
  ds_read_b64_tr_b16 v[64:65], v8 offset:24576
  ds_read_b64_tr_b16 v[66:67], v8 offset:25344
  v_mfma_f32_16x16x32_bf16 v[20:23], v[100:103], v[120:123], v[20:23]
  ds_read_b64_tr_b16 v[68:69], v9 offset:24608
  ds_read_b64_tr_b16 v[70:71], v9 offset:25376
  v_mfma_f32_16x16x32_bf16 v[44:47], v[100:103], v[124:127], v[44:47]
  ds_read_b64_tr_b16 v[72:73], v8 offset:24640
  ds_read_b64_tr_b16 v[74:75], v8 offset:25408
  v_mfma_f32_16x16x32_bf16 v[24:27], v[104:107], v[120:123], v[24:27]
  ds_read_b64_tr_b16 v[76:77], v8 offset:30720
  ds_read_b64_tr_b16 v[78:79], v8 offset:31488
  v_mfma_f32_16x16x32_bf16 v[48:51], v[104:107], v[124:127], v[48:51]
  ds_read_b64_tr_b16 v[80:81], v9 offset:30752
  ds_read_b64_tr_b16 v[82:83], v9 offset:31520
  v_mfma_f32_16x16x32_bf16 v[28:31], v[108:111], v[120:123], v[28:31]
  ds_read_b64_tr_b16 v[84:85], v8 offset:30784
  ds_read_b64_tr_b16 v[86:87], v8 offset:31552
  v_mfma_f32_16x16x32_bf16 v[52:55], v[108:111], v[124:127], v[52:55]
  v_mfma_f32_16x16x32_bf16 v[32:35], v[112:115], v[120:123], v[32:35]
  v_mfma_f32_16x16x32_bf16 v[56:59], v[112:115], v[124:127], v[56:59]
  v_mfma_f32_16x16x32_bf16 v[36:39], v[116:119], v[120:123], v[36:39]
  v_mfma_f32_16x16x32_bf16 v[60:63], v[116:119], v[124:127], v[60:63]
  s_waitcnt lgkmcnt(0)
  v_mfma_f32_16x16x32_bf16 v[16:19], v[64:67], v[88:91], v[16:19]
  ds_read_b128 v[120:123], v12 offset:49152
  ds_read_b128 v[124:127], v12 offset:51200
  v_mfma_f32_16x16x32_bf16 v[40:43], v[64:67], v[92:95], v[40:43]
  ds_read_b64_tr_b16 v[96:97], v8 offset:36864
  ds_read_b64_tr_b16 v[98:99], v8 offset:37632
  v_mfma_f32_16x16x32_bf16 v[20:23], v[68:71], v[88:91], v[20:23]
  ds_read_b64_tr_b16 v[100:101], v9 offset:36896
  ds_read_b64_tr_b16 v[102:103], v9 offset:37664
  v_mfma_f32_16x16x32_bf16 v[44:47], v[68:71], v[92:95], v[44:47]
  ds_read_b64_tr_b16 v[104:105], v8 offset:36928
  ds_read_b64_tr_b16 v[106:107], v8 offset:37696
  v_mfma_f32_16x16x32_bf16 v[24:27], v[72:75], v[88:91], v[24:27]
  ds_read_b64_tr_b16 v[108:109], v8 offset:43008
  ds_read_b64_tr_b16 v[110:111], v8 offset:43776
  v_mfma_f32_16x16x32_bf16 v[48:51], v[72:75], v[92:95], v[48:51]
  ds_read_b64_tr_b16 v[112:113], v9 offset:43040
  ds_read_b64_tr_b16 v[114:115], v9 offset:43808
  v_mfma_f32_16x16x32_bf16 v[28:31], v[76:79], v[88:91], v[28:31]
  ds_read_b64_tr_b16 v[116:117], v8 offset:43072
  ds_read_b64_tr_b16 v[118:119], v8 offset:43840
  v_mfma_f32_16x16x32_bf16 v[52:55], v[76:79], v[92:95], v[52:55]
  v_mfma_f32_16x16x32_bf16 v[32:35], v[80:83], v[88:91], v[32:35]
  v_mfma_f32_16x16x32_bf16 v[56:59], v[80:83], v[92:95], v[56:59]
  v_mfma_f32_16x16x32_bf16 v[36:39], v[84:87], v[88:91], v[36:39]
  v_mfma_f32_16x16x32_bf16 v[60:63], v[84:87], v[92:95], v[60:63]
  s_waitcnt lgkmcnt(0)
  s_barrier
  v_mfma_f32_16x16x32_bf16 v[16:19], v[96:99], v[120:123], v[16:19]
  ds_read_b128 v[88:91], v11 offset:0
  ds_read_b128 v[92:95], v11 offset:2048
  v_mfma_f32_16x16x32_bf16 v[40:43], v[96:99], v[124:127], v[40:43]
  ds_read_b64_tr_b16 v[64:65], v6 offset:0
  ds_read_b64_tr_b16 v[66:67], v6 offset:768
  v_mfma_f32_16x16x32_bf16 v[20:23], v[100:103], v[120:123], v[20:23]
  ds_read_b64_tr_b16 v[68:69], v7 offset:32
  ds_read_b64_tr_b16 v[70:71], v7 offset:800
  v_mfma_f32_16x16x32_bf16 v[44:47], v[100:103], v[124:127], v[44:47]
  ds_read_b64_tr_b16 v[72:73], v6 offset:64
  ds_read_b64_tr_b16 v[74:75], v6 offset:832
  v_mfma_f32_16x16x32_bf16 v[24:27], v[104:107], v[120:123], v[24:27]
  ds_read_b64_tr_b16 v[76:77], v6 offset:6144
  ds_read_b64_tr_b16 v[78:79], v6 offset:6912
  v_mfma_f32_16x16x32_bf16 v[48:51], v[104:107], v[124:127], v[48:51]
  ds_read_b64_tr_b16 v[80:81], v7 offset:6176
  ds_read_b64_tr_b16 v[82:83], v7 offset:6944
  v_mfma_f32_16x16x32_bf16 v[28:31], v[108:111], v[120:123], v[28:31]
  ds_read_b64_tr_b16 v[84:85], v6 offset:6208
  ds_read_b64_tr_b16 v[86:87], v6 offset:6976
  v_mfma_f32_16x16x32_bf16 v[52:55], v[108:111], v[124:127], v[52:55]
  v_mfma_f32_16x16x32_bf16 v[32:35], v[112:115], v[120:123], v[32:35]
  v_mfma_f32_16x16x32_bf16 v[56:59], v[112:115], v[124:127], v[56:59]
  v_mfma_f32_16x16x32_bf16 v[36:39], v[116:119], v[120:123], v[36:39]
  v_mfma_f32_16x16x32_bf16 v[60:63], v[116:119], v[124:127], v[60:63]
  s_waitcnt lgkmcnt(0)
  v_mfma_f32_16x16x32_bf16 v[16:19], v[64:67], v[88:91], v[16:19]
  ds_read_b128 v[120:123], v12 offset:0
  ds_read_b128 v[124:127], v12 offset:2048
  v_mfma_f32_16x16x32_bf16 v[40:43], v[64:67], v[92:95], v[40:43]
  ds_read_b64_tr_b16 v[96:97], v6 offset:12288
  ds_read_b64_tr_b16 v[98:99], v6 offset:13056
  v_mfma_f32_16x16x32_bf16 v[20:23], v[68:71], v[88:91], v[20:23]
  ds_read_b64_tr_b16 v[100:101], v7 offset:12320
  ds_read_b64_tr_b16 v[102:103], v7 offset:13088
  v_mfma_f32_16x16x32_bf16 v[44:47], v[68:71], v[92:95], v[44:47]
  ds_read_b64_tr_b16 v[104:105], v6 offset:12352
  ds_read_b64_tr_b16 v[106:107], v6 offset:13120
  v_mfma_f32_16x16x32_bf16 v[24:27], v[72:75], v[88:91], v[24:27]
  ds_read_b64_tr_b16 v[108:109], v6 offset:18432
  ds_read_b64_tr_b16 v[110:111], v6 offset:19200
  v_mfma_f32_16x16x32_bf16 v[48:51], v[72:75], v[92:95], v[48:51]
  ds_read_b64_tr_b16 v[112:113], v7 offset:18464
  ds_read_b64_tr_b16 v[114:115], v7 offset:19232
  v_mfma_f32_16x16x32_bf16 v[28:31], v[76:79], v[88:91], v[28:31]
  ds_read_b64_tr_b16 v[116:117], v6 offset:18496
  ds_read_b64_tr_b16 v[118:119], v6 offset:19264
  v_mfma_f32_16x16x32_bf16 v[52:55], v[76:79], v[92:95], v[52:55]
  v_mfma_f32_16x16x32_bf16 v[32:35], v[80:83], v[88:91], v[32:35]
  v_mfma_f32_16x16x32_bf16 v[56:59], v[80:83], v[92:95], v[56:59]
  v_mfma_f32_16x16x32_bf16 v[36:39], v[84:87], v[88:91], v[36:39]
  v_mfma_f32_16x16x32_bf16 v[60:63], v[84:87], v[92:95], v[60:63]
  s_waitcnt lgkmcnt(0)
  s_barrier
  v_mfma_f32_16x16x32_bf16 v[16:19], v[96:99], v[120:123], v[16:19]
  ds_read_b128 v[88:91], v11 offset:16384
  ds_read_b128 v[92:95], v11 offset:18432
  v_mfma_f32_16x16x32_bf16 v[40:43], v[96:99], v[124:127], v[40:43]
  ds_read_b64_tr_b16 v[64:65], v6 offset:24576
  ds_read_b64_tr_b16 v[66:67], v6 offset:25344
  v_mfma_f32_16x16x32_bf16 v[20:23], v[100:103], v[120:123], v[20:23]
  ds_read_b64_tr_b16 v[68:69], v7 offset:24608
  ds_read_b64_tr_b16 v[70:71], v7 offset:25376
  v_mfma_f32_16x16x32_bf16 v[44:47], v[100:103], v[124:127], v[44:47]
  ds_read_b64_tr_b16 v[72:73], v6 offset:24640
  ds_read_b64_tr_b16 v[74:75], v6 offset:25408
  v_mfma_f32_16x16x32_bf16 v[24:27], v[104:107], v[120:123], v[24:27]
  ds_read_b64_tr_b16 v[76:77], v6 offset:30720
  ds_read_b64_tr_b16 v[78:79], v6 offset:31488
  v_mfma_f32_16x16x32_bf16 v[48:51], v[104:107], v[124:127], v[48:51]
  ds_read_b64_tr_b16 v[80:81], v7 offset:30752
  ds_read_b64_tr_b16 v[82:83], v7 offset:31520
  v_mfma_f32_16x16x32_bf16 v[28:31], v[108:111], v[120:123], v[28:31]
  ds_read_b64_tr_b16 v[84:85], v6 offset:30784
  ds_read_b64_tr_b16 v[86:87], v6 offset:31552
  v_mfma_f32_16x16x32_bf16 v[52:55], v[108:111], v[124:127], v[52:55]
  v_mfma_f32_16x16x32_bf16 v[32:35], v[112:115], v[120:123], v[32:35]
  v_mfma_f32_16x16x32_bf16 v[56:59], v[112:115], v[124:127], v[56:59]
  v_mfma_f32_16x16x32_bf16 v[36:39], v[116:119], v[120:123], v[36:39]
  v_mfma_f32_16x16x32_bf16 v[60:63], v[116:119], v[124:127], v[60:63]
  s_waitcnt lgkmcnt(0)
  v_mfma_f32_16x16x32_bf16 v[16:19], v[64:67], v[88:91], v[16:19]
  ds_read_b128 v[120:123], v12 offset:16384
  ds_read_b128 v[124:127], v12 offset:18432
  v_mfma_f32_16x16x32_bf16 v[40:43], v[64:67], v[92:95], v[40:43]
  ds_read_b64_tr_b16 v[96:97], v6 offset:36864
  ds_read_b64_tr_b16 v[98:99], v6 offset:37632
  v_mfma_f32_16x16x32_bf16 v[20:23], v[68:71], v[88:91], v[20:23]
  ds_read_b64_tr_b16 v[100:101], v7 offset:36896
  ds_read_b64_tr_b16 v[102:103], v7 offset:37664
  v_mfma_f32_16x16x32_bf16 v[44:47], v[68:71], v[92:95], v[44:47]
  ds_read_b64_tr_b16 v[104:105], v6 offset:36928
  ds_read_b64_tr_b16 v[106:107], v6 offset:37696
  v_mfma_f32_16x16x32_bf16 v[24:27], v[72:75], v[88:91], v[24:27]
  ds_read_b64_tr_b16 v[108:109], v6 offset:43008
  ds_read_b64_tr_b16 v[110:111], v6 offset:43776
  v_mfma_f32_16x16x32_bf16 v[48:51], v[72:75], v[92:95], v[48:51]
  ds_read_b64_tr_b16 v[112:113], v7 offset:43040
  ds_read_b64_tr_b16 v[114:115], v7 offset:43808
  v_mfma_f32_16x16x32_bf16 v[28:31], v[76:79], v[88:91], v[28:31]
  ds_read_b64_tr_b16 v[116:117], v6 offset:43072
  ds_read_b64_tr_b16 v[118:119], v6 offset:43840
  v_mfma_f32_16x16x32_bf16 v[52:55], v[76:79], v[92:95], v[52:55]
  v_mfma_f32_16x16x32_bf16 v[32:35], v[80:83], v[88:91], v[32:35]
  v_mfma_f32_16x16x32_bf16 v[56:59], v[80:83], v[92:95], v[56:59]
  v_mfma_f32_16x16x32_bf16 v[36:39], v[84:87], v[88:91], v[36:39]
  v_mfma_f32_16x16x32_bf16 v[60:63], v[84:87], v[92:95], v[60:63]
  s_waitcnt lgkmcnt(0)
  s_barrier
  v_mfma_f32_16x16x32_bf16 v[16:19], v[96:99], v[120:123], v[16:19]
  ds_read_b128 v[88:91], v11 offset:32768
  ds_read_b128 v[92:95], v11 offset:34816
  v_mfma_f32_16x16x32_bf16 v[40:43], v[96:99], v[124:127], v[40:43]
  ds_read_b64_tr_b16 v[64:65], v8 offset:0
  ds_read_b64_tr_b16 v[66:67], v8 offset:768
  v_mfma_f32_16x16x32_bf16 v[20:23], v[100:103], v[120:123], v[20:23]
  ds_read_b64_tr_b16 v[68:69], v9 offset:32
  ds_read_b64_tr_b16 v[70:71], v9 offset:800
  v_mfma_f32_16x16x32_bf16 v[44:47], v[100:103], v[124:127], v[44:47]
  ds_read_b64_tr_b16 v[72:73], v8 offset:64
  ds_read_b64_tr_b16 v[74:75], v8 offset:832
  v_mfma_f32_16x16x32_bf16 v[24:27], v[104:107], v[120:123], v[24:27]
  ds_read_b64_tr_b16 v[76:77], v8 offset:6144
  ds_read_b64_tr_b16 v[78:79], v8 offset:6912
  v_mfma_f32_16x16x32_bf16 v[48:51], v[104:107], v[124:127], v[48:51]
  ds_read_b64_tr_b16 v[80:81], v9 offset:6176
  ds_read_b64_tr_b16 v[82:83], v9 offset:6944
  v_mfma_f32_16x16x32_bf16 v[28:31], v[108:111], v[120:123], v[28:31]
  ds_read_b64_tr_b16 v[84:85], v8 offset:6208
  ds_read_b64_tr_b16 v[86:87], v8 offset:6976
  v_mfma_f32_16x16x32_bf16 v[52:55], v[108:111], v[124:127], v[52:55]
  v_mfma_f32_16x16x32_bf16 v[32:35], v[112:115], v[120:123], v[32:35]
  v_mfma_f32_16x16x32_bf16 v[56:59], v[112:115], v[124:127], v[56:59]
  v_mfma_f32_16x16x32_bf16 v[36:39], v[116:119], v[120:123], v[36:39]
  v_mfma_f32_16x16x32_bf16 v[60:63], v[116:119], v[124:127], v[60:63]
  s_waitcnt lgkmcnt(0)
  v_mfma_f32_16x16x32_bf16 v[16:19], v[64:67], v[88:91], v[16:19]
  ds_read_b128 v[120:123], v12 offset:32768
  ds_read_b128 v[124:127], v12 offset:34816
  v_mfma_f32_16x16x32_bf16 v[40:43], v[64:67], v[92:95], v[40:43]
  ds_read_b64_tr_b16 v[96:97], v8 offset:12288
  ds_read_b64_tr_b16 v[98:99], v8 offset:13056
  v_mfma_f32_16x16x32_bf16 v[20:23], v[68:71], v[88:91], v[20:23]
  ds_read_b64_tr_b16 v[100:101], v9 offset:12320
  ds_read_b64_tr_b16 v[102:103], v9 offset:13088
  v_mfma_f32_16x16x32_bf16 v[44:47], v[68:71], v[92:95], v[44:47]
  ds_read_b64_tr_b16 v[104:105], v8 offset:12352
  ds_read_b64_tr_b16 v[106:107], v8 offset:13120
  v_mfma_f32_16x16x32_bf16 v[24:27], v[72:75], v[88:91], v[24:27]
  ds_read_b64_tr_b16 v[108:109], v8 offset:18432
  ds_read_b64_tr_b16 v[110:111], v8 offset:19200
  v_mfma_f32_16x16x32_bf16 v[48:51], v[72:75], v[92:95], v[48:51]
  ds_read_b64_tr_b16 v[112:113], v9 offset:18464
  ds_read_b64_tr_b16 v[114:115], v9 offset:19232
  v_mfma_f32_16x16x32_bf16 v[28:31], v[76:79], v[88:91], v[28:31]
  ds_read_b64_tr_b16 v[116:117], v8 offset:18496
  ds_read_b64_tr_b16 v[118:119], v8 offset:19264
  v_mfma_f32_16x16x32_bf16 v[52:55], v[76:79], v[92:95], v[52:55]
  v_mfma_f32_16x16x32_bf16 v[32:35], v[80:83], v[88:91], v[32:35]
  v_mfma_f32_16x16x32_bf16 v[56:59], v[80:83], v[92:95], v[56:59]
  v_mfma_f32_16x16x32_bf16 v[36:39], v[84:87], v[88:91], v[36:39]
  v_mfma_f32_16x16x32_bf16 v[60:63], v[84:87], v[92:95], v[60:63]
  s_waitcnt lgkmcnt(0)
  s_barrier
  v_mfma_f32_16x16x32_bf16 v[16:19], v[96:99], v[120:123], v[16:19]
  ds_read_b128 v[88:91], v11 offset:49152
  ds_read_b128 v[92:95], v11 offset:51200
  v_mfma_f32_16x16x32_bf16 v[40:43], v[96:99], v[124:127], v[40:43]
  ds_read_b64_tr_b16 v[64:65], v8 offset:24576
  ds_read_b64_tr_b16 v[66:67], v8 offset:25344
  v_mfma_f32_16x16x32_bf16 v[20:23], v[100:103], v[120:123], v[20:23]
  ds_read_b64_tr_b16 v[68:69], v9 offset:24608
  ds_read_b64_tr_b16 v[70:71], v9 offset:25376
  v_mfma_f32_16x16x32_bf16 v[44:47], v[100:103], v[124:127], v[44:47]
  ds_read_b64_tr_b16 v[72:73], v8 offset:24640
  ds_read_b64_tr_b16 v[74:75], v8 offset:25408
  v_mfma_f32_16x16x32_bf16 v[24:27], v[104:107], v[120:123], v[24:27]
  ds_read_b64_tr_b16 v[76:77], v8 offset:30720
  ds_read_b64_tr_b16 v[78:79], v8 offset:31488
  v_mfma_f32_16x16x32_bf16 v[48:51], v[104:107], v[124:127], v[48:51]
  ds_read_b64_tr_b16 v[80:81], v9 offset:30752
  ds_read_b64_tr_b16 v[82:83], v9 offset:31520
  v_mfma_f32_16x16x32_bf16 v[28:31], v[108:111], v[120:123], v[28:31]
  ds_read_b64_tr_b16 v[84:85], v8 offset:30784
  ds_read_b64_tr_b16 v[86:87], v8 offset:31552
  v_mfma_f32_16x16x32_bf16 v[52:55], v[108:111], v[124:127], v[52:55]
  v_mfma_f32_16x16x32_bf16 v[32:35], v[112:115], v[120:123], v[32:35]
  v_mfma_f32_16x16x32_bf16 v[56:59], v[112:115], v[124:127], v[56:59]
  v_mfma_f32_16x16x32_bf16 v[36:39], v[116:119], v[120:123], v[36:39]
  v_mfma_f32_16x16x32_bf16 v[60:63], v[116:119], v[124:127], v[60:63]
  s_waitcnt lgkmcnt(0)
  v_mfma_f32_16x16x32_bf16 v[16:19], v[64:67], v[88:91], v[16:19]
  ds_read_b128 v[120:123], v12 offset:49152
  ds_read_b128 v[124:127], v12 offset:51200
  v_mfma_f32_16x16x32_bf16 v[40:43], v[64:67], v[92:95], v[40:43]
  ds_read_b64_tr_b16 v[96:97], v8 offset:36864
  ds_read_b64_tr_b16 v[98:99], v8 offset:37632
  v_mfma_f32_16x16x32_bf16 v[20:23], v[68:71], v[88:91], v[20:23]
  ds_read_b64_tr_b16 v[100:101], v9 offset:36896
  ds_read_b64_tr_b16 v[102:103], v9 offset:37664
  v_mfma_f32_16x16x32_bf16 v[44:47], v[68:71], v[92:95], v[44:47]
  ds_read_b64_tr_b16 v[104:105], v8 offset:36928
  ds_read_b64_tr_b16 v[106:107], v8 offset:37696
  v_mfma_f32_16x16x32_bf16 v[24:27], v[72:75], v[88:91], v[24:27]
  ds_read_b64_tr_b16 v[108:109], v8 offset:43008
  ds_read_b64_tr_b16 v[110:111], v8 offset:43776
  v_mfma_f32_16x16x32_bf16 v[48:51], v[72:75], v[92:95], v[48:51]
  ds_read_b64_tr_b16 v[112:113], v9 offset:43040
  ds_read_b64_tr_b16 v[114:115], v9 offset:43808
  v_mfma_f32_16x16x32_bf16 v[28:31], v[76:79], v[88:91], v[28:31]
  ds_read_b64_tr_b16 v[116:117], v8 offset:43072
  ds_read_b64_tr_b16 v[118:119], v8 offset:43840
  v_mfma_f32_16x16x32_bf16 v[52:55], v[76:79], v[92:95], v[52:55]
  v_mfma_f32_16x16x32_bf16 v[32:35], v[80:83], v[88:91], v[32:35]
  v_mfma_f32_16x16x32_bf16 v[56:59], v[80:83], v[92:95], v[56:59]
  v_mfma_f32_16x16x32_bf16 v[36:39], v[84:87], v[88:91], v[36:39]
  v_mfma_f32_16x16x32_bf16 v[60:63], v[84:87], v[92:95], v[60:63]
  s_waitcnt lgkmcnt(0)
  s_barrier
  v_mfma_f32_16x16x32_bf16 v[16:19], v[96:99], v[120:123], v[16:19]
  ds_read_b128 v[88:91], v11 offset:0
  ds_read_b128 v[92:95], v11 offset:2048
  v_mfma_f32_16x16x32_bf16 v[40:43], v[96:99], v[124:127], v[40:43]
  ds_read_b64_tr_b16 v[64:65], v6 offset:0
  ds_read_b64_tr_b16 v[66:67], v6 offset:768
  v_mfma_f32_16x16x32_bf16 v[20:23], v[100:103], v[120:123], v[20:23]
  ds_read_b64_tr_b16 v[68:69], v7 offset:32
  ds_read_b64_tr_b16 v[70:71], v7 offset:800
  v_mfma_f32_16x16x32_bf16 v[44:47], v[100:103], v[124:127], v[44:47]
  ds_read_b64_tr_b16 v[72:73], v6 offset:64
  ds_read_b64_tr_b16 v[74:75], v6 offset:832
  v_mfma_f32_16x16x32_bf16 v[24:27], v[104:107], v[120:123], v[24:27]
  ds_read_b64_tr_b16 v[76:77], v6 offset:6144
  ds_read_b64_tr_b16 v[78:79], v6 offset:6912
  v_mfma_f32_16x16x32_bf16 v[48:51], v[104:107], v[124:127], v[48:51]
  ds_read_b64_tr_b16 v[80:81], v7 offset:6176
  ds_read_b64_tr_b16 v[82:83], v7 offset:6944
  v_mfma_f32_16x16x32_bf16 v[28:31], v[108:111], v[120:123], v[28:31]
  ds_read_b64_tr_b16 v[84:85], v6 offset:6208
  ds_read_b64_tr_b16 v[86:87], v6 offset:6976
  v_mfma_f32_16x16x32_bf16 v[52:55], v[108:111], v[124:127], v[52:55]
  v_mfma_f32_16x16x32_bf16 v[32:35], v[112:115], v[120:123], v[32:35]
  v_mfma_f32_16x16x32_bf16 v[56:59], v[112:115], v[124:127], v[56:59]
  v_mfma_f32_16x16x32_bf16 v[36:39], v[116:119], v[120:123], v[36:39]
  v_mfma_f32_16x16x32_bf16 v[60:63], v[116:119], v[124:127], v[60:63]
  s_waitcnt lgkmcnt(0)
  v_mfma_f32_16x16x32_bf16 v[16:19], v[64:67], v[88:91], v[16:19]
  ds_read_b128 v[120:123], v12 offset:0
  ds_read_b128 v[124:127], v12 offset:2048
  v_mfma_f32_16x16x32_bf16 v[40:43], v[64:67], v[92:95], v[40:43]
  ds_read_b64_tr_b16 v[96:97], v6 offset:12288
  ds_read_b64_tr_b16 v[98:99], v6 offset:13056
  v_mfma_f32_16x16x32_bf16 v[20:23], v[68:71], v[88:91], v[20:23]
  ds_read_b64_tr_b16 v[100:101], v7 offset:12320
  ds_read_b64_tr_b16 v[102:103], v7 offset:13088
  v_mfma_f32_16x16x32_bf16 v[44:47], v[68:71], v[92:95], v[44:47]
  ds_read_b64_tr_b16 v[104:105], v6 offset:12352
  ds_read_b64_tr_b16 v[106:107], v6 offset:13120
  v_mfma_f32_16x16x32_bf16 v[24:27], v[72:75], v[88:91], v[24:27]
  ds_read_b64_tr_b16 v[108:109], v6 offset:18432
  ds_read_b64_tr_b16 v[110:111], v6 offset:19200
  v_mfma_f32_16x16x32_bf16 v[48:51], v[72:75], v[92:95], v[48:51]
  ds_read_b64_tr_b16 v[112:113], v7 offset:18464
  ds_read_b64_tr_b16 v[114:115], v7 offset:19232
  v_mfma_f32_16x16x32_bf16 v[28:31], v[76:79], v[88:91], v[28:31]
  ds_read_b64_tr_b16 v[116:117], v6 offset:18496
  ds_read_b64_tr_b16 v[118:119], v6 offset:19264
  v_mfma_f32_16x16x32_bf16 v[52:55], v[76:79], v[92:95], v[52:55]
  v_mfma_f32_16x16x32_bf16 v[32:35], v[80:83], v[88:91], v[32:35]
  v_mfma_f32_16x16x32_bf16 v[56:59], v[80:83], v[92:95], v[56:59]
  v_mfma_f32_16x16x32_bf16 v[36:39], v[84:87], v[88:91], v[36:39]
  v_mfma_f32_16x16x32_bf16 v[60:63], v[84:87], v[92:95], v[60:63]
  s_waitcnt lgkmcnt(0)
  s_barrier
  v_mfma_f32_16x16x32_bf16 v[16:19], v[96:99], v[120:123], v[16:19]
  ds_read_b128 v[88:91], v11 offset:16384
  ds_read_b128 v[92:95], v11 offset:18432
  v_mfma_f32_16x16x32_bf16 v[40:43], v[96:99], v[124:127], v[40:43]
  ds_read_b64_tr_b16 v[64:65], v6 offset:24576
  ds_read_b64_tr_b16 v[66:67], v6 offset:25344
  v_mfma_f32_16x16x32_bf16 v[20:23], v[100:103], v[120:123], v[20:23]
  ds_read_b64_tr_b16 v[68:69], v7 offset:24608
  ds_read_b64_tr_b16 v[70:71], v7 offset:25376
  v_mfma_f32_16x16x32_bf16 v[44:47], v[100:103], v[124:127], v[44:47]
  ds_read_b64_tr_b16 v[72:73], v6 offset:24640
  ds_read_b64_tr_b16 v[74:75], v6 offset:25408
  v_mfma_f32_16x16x32_bf16 v[24:27], v[104:107], v[120:123], v[24:27]
  ds_read_b64_tr_b16 v[76:77], v6 offset:30720
  ds_read_b64_tr_b16 v[78:79], v6 offset:31488
  v_mfma_f32_16x16x32_bf16 v[48:51], v[104:107], v[124:127], v[48:51]
  ds_read_b64_tr_b16 v[80:81], v7 offset:30752
  ds_read_b64_tr_b16 v[82:83], v7 offset:31520
  v_mfma_f32_16x16x32_bf16 v[28:31], v[108:111], v[120:123], v[28:31]
  ds_read_b64_tr_b16 v[84:85], v6 offset:30784
  ds_read_b64_tr_b16 v[86:87], v6 offset:31552
  v_mfma_f32_16x16x32_bf16 v[52:55], v[108:111], v[124:127], v[52:55]
  v_mfma_f32_16x16x32_bf16 v[32:35], v[112:115], v[120:123], v[32:35]
  v_mfma_f32_16x16x32_bf16 v[56:59], v[112:115], v[124:127], v[56:59]
  v_mfma_f32_16x16x32_bf16 v[36:39], v[116:119], v[120:123], v[36:39]
  v_mfma_f32_16x16x32_bf16 v[60:63], v[116:119], v[124:127], v[60:63]
  s_waitcnt lgkmcnt(0)
  v_mfma_f32_16x16x32_bf16 v[16:19], v[64:67], v[88:91], v[16:19]
  ds_read_b128 v[120:123], v12 offset:16384
  ds_read_b128 v[124:127], v12 offset:18432
  v_mfma_f32_16x16x32_bf16 v[40:43], v[64:67], v[92:95], v[40:43]
  ds_read_b64_tr_b16 v[96:97], v6 offset:36864
  ds_read_b64_tr_b16 v[98:99], v6 offset:37632
  v_mfma_f32_16x16x32_bf16 v[20:23], v[68:71], v[88:91], v[20:23]
  ds_read_b64_tr_b16 v[100:101], v7 offset:36896
  ds_read_b64_tr_b16 v[102:103], v7 offset:37664
  v_mfma_f32_16x16x32_bf16 v[44:47], v[68:71], v[92:95], v[44:47]
  ds_read_b64_tr_b16 v[104:105], v6 offset:36928
  ds_read_b64_tr_b16 v[106:107], v6 offset:37696
  v_mfma_f32_16x16x32_bf16 v[24:27], v[72:75], v[88:91], v[24:27]
  ds_read_b64_tr_b16 v[108:109], v6 offset:43008
  ds_read_b64_tr_b16 v[110:111], v6 offset:43776
  v_mfma_f32_16x16x32_bf16 v[48:51], v[72:75], v[92:95], v[48:51]
  ds_read_b64_tr_b16 v[112:113], v7 offset:43040
  ds_read_b64_tr_b16 v[114:115], v7 offset:43808
  v_mfma_f32_16x16x32_bf16 v[28:31], v[76:79], v[88:91], v[28:31]
  ds_read_b64_tr_b16 v[116:117], v6 offset:43072
  ds_read_b64_tr_b16 v[118:119], v6 offset:43840
  v_mfma_f32_16x16x32_bf16 v[52:55], v[76:79], v[92:95], v[52:55]
  v_mfma_f32_16x16x32_bf16 v[32:35], v[80:83], v[88:91], v[32:35]
  v_mfma_f32_16x16x32_bf16 v[56:59], v[80:83], v[92:95], v[56:59]
  v_mfma_f32_16x16x32_bf16 v[36:39], v[84:87], v[88:91], v[36:39]
  v_mfma_f32_16x16x32_bf16 v[60:63], v[84:87], v[92:95], v[60:63]
  s_waitcnt lgkmcnt(0)
  s_barrier
  v_mfma_f32_16x16x32_bf16 v[16:19], v[96:99], v[120:123], v[16:19]
  v_mfma_f32_16x16x32_bf16 v[40:43], v[96:99], v[124:127], v[40:43]
  v_mfma_f32_16x16x32_bf16 v[20:23], v[100:103], v[120:123], v[20:23]
  v_mfma_f32_16x16x32_bf16 v[44:47], v[100:103], v[124:127], v[44:47]
  v_mfma_f32_16x16x32_bf16 v[24:27], v[104:107], v[120:123], v[24:27]
  v_mfma_f32_16x16x32_bf16 v[48:51], v[104:107], v[124:127], v[48:51]
  v_mfma_f32_16x16x32_bf16 v[28:31], v[108:111], v[120:123], v[28:31]
  v_mfma_f32_16x16x32_bf16 v[52:55], v[108:111], v[124:127], v[52:55]
  v_mfma_f32_16x16x32_bf16 v[32:35], v[112:115], v[120:123], v[32:35]
  v_mfma_f32_16x16x32_bf16 v[56:59], v[112:115], v[124:127], v[56:59]
  v_mfma_f32_16x16x32_bf16 v[36:39], v[116:119], v[120:123], v[36:39]
  v_mfma_f32_16x16x32_bf16 v[60:63], v[116:119], v[124:127], v[60:63]
  s_mov_b32 s30, 0xbdd2d3e8
  s_mov_b32 s31, 0xbdd2d3e8
  v_mov_b32 v10, 0xc0135761
  v_mov_b32 v11, 0xc0135761
  s_lshl_b32 s29, s50, 3
  s_lshl_b32 s28, s27, 1
  s_add_u32 s29, s29, s28
  s_mul_i32 s29, s29, 49152
  s_mul_i32 s28, s51, 3072
  s_add_u32 s29, s29, s28
  s_mul_i32 s28, s26, 1536
  s_add_u32 s29, s29, s28
  s_add_u32 s29, s29, 16777216
  v_bfe_u32 v7, v2, 4, 1
  v_mul_u32_u24 v7, 49152, v7
  v_lshrrev_b32 v8, 5, v2
  v_lshl_add_u32 v7, v8, 8, v7
  v_and_b32 v8, 15, v2
  v_lshl_add_u32 v7, v8, 4, v7
  v_pk_mul_f32 v[64:65], v[16:17], v[16:17]
  v_pk_mul_f32 v[66:67], v[18:19], v[18:19]
  v_pk_mul_f32 v[68:69], v[20:21], v[20:21]
  v_pk_mul_f32 v[70:71], v[22:23], v[22:23]
  v_pk_mul_f32 v[72:73], v[24:25], v[24:25]
  v_pk_mul_f32 v[74:75], v[26:27], v[26:27]
  v_pk_fma_f32 v[64:65], v[64:65], s[30:31], v[10:11]
  v_pk_fma_f32 v[66:67], v[66:67], s[30:31], v[10:11]
  v_pk_fma_f32 v[68:69], v[68:69], s[30:31], v[10:11]
  v_pk_fma_f32 v[70:71], v[70:71], s[30:31], v[10:11]
  v_pk_fma_f32 v[72:73], v[72:73], s[30:31], v[10:11]
  v_pk_fma_f32 v[74:75], v[74:75], s[30:31], v[10:11]
  v_pk_mul_f32 v[64:65], v[64:65], v[16:17]
  v_pk_mul_f32 v[66:67], v[66:67], v[18:19]
  v_pk_mul_f32 v[68:69], v[68:69], v[20:21]
  v_pk_mul_f32 v[70:71], v[70:71], v[22:23]
  v_pk_mul_f32 v[72:73], v[72:73], v[24:25]
  v_pk_mul_f32 v[74:75], v[74:75], v[26:27]
  v_exp_f32 v64, v64
  v_exp_f32 v65, v65
  v_pk_mul_f32 v[16:17], v[16:17], v[28:29]
  v_exp_f32 v66, v66
  v_exp_f32 v67, v67
  v_pk_mul_f32 v[18:19], v[18:19], v[30:31]
  v_exp_f32 v68, v68
  v_exp_f32 v69, v69
  v_pk_mul_f32 v[20:21], v[20:21], v[32:33]
  v_exp_f32 v70, v70
  v_exp_f32 v71, v71
  v_pk_mul_f32 v[22:23], v[22:23], v[34:35]
  v_exp_f32 v72, v72
  v_exp_f32 v73, v73
  v_pk_mul_f32 v[24:25], v[24:25], v[36:37]
  v_exp_f32 v74, v74
  v_exp_f32 v75, v75
  v_pk_mul_f32 v[26:27], v[26:27], v[38:39]
  v_pk_add_f32 v[64:65], v[64:65], 1.0 op_sel_hi:[1,0]
  v_pk_add_f32 v[66:67], v[66:67], 1.0 op_sel_hi:[1,0]
  v_pk_add_f32 v[68:69], v[68:69], 1.0 op_sel_hi:[1,0]
  v_pk_add_f32 v[70:71], v[70:71], 1.0 op_sel_hi:[1,0]
  v_pk_add_f32 v[72:73], v[72:73], 1.0 op_sel_hi:[1,0]
  v_pk_add_f32 v[74:75], v[74:75], 1.0 op_sel_hi:[1,0]
  v_rcp_f32 v64, v64
  v_rcp_f32 v65, v65
  v_rcp_f32 v66, v66
  v_rcp_f32 v67, v67
  v_rcp_f32 v68, v68
  v_rcp_f32 v69, v69
  v_rcp_f32 v70, v70
  v_rcp_f32 v71, v71
  v_rcp_f32 v72, v72
  v_rcp_f32 v73, v73
  v_rcp_f32 v74, v74
  v_rcp_f32 v75, v75
  v_pk_mul_f32 v[16:17], v[16:17], v[64:65]
  v_pk_mul_f32 v[18:19], v[18:19], v[66:67]
  v_pk_mul_f32 v[20:21], v[20:21], v[68:69]
  v_pk_mul_f32 v[22:23], v[22:23], v[70:71]
  v_pk_mul_f32 v[24:25], v[24:25], v[72:73]
  v_pk_mul_f32 v[26:27], v[26:27], v[74:75]
  v_cvt_pk_bf16_f32 v96, v16, v17
  v_cvt_pk_bf16_f32 v97, v18, v19
  v_cvt_pk_bf16_f32 v100, v20, v21
  v_cvt_pk_bf16_f32 v101, v22, v23
  v_cvt_pk_bf16_f32 v104, v24, v25
  v_cvt_pk_bf16_f32 v105, v26, v27
  v_pk_mul_f32 v[80:81], v[40:41], v[40:41]
  v_pk_mul_f32 v[82:83], v[42:43], v[42:43]
  v_pk_mul_f32 v[84:85], v[44:45], v[44:45]
  v_pk_mul_f32 v[86:87], v[46:47], v[46:47]
  v_pk_mul_f32 v[88:89], v[48:49], v[48:49]
  v_pk_mul_f32 v[90:91], v[50:51], v[50:51]
  v_pk_fma_f32 v[80:81], v[80:81], s[30:31], v[10:11]
  v_pk_fma_f32 v[82:83], v[82:83], s[30:31], v[10:11]
  v_pk_fma_f32 v[84:85], v[84:85], s[30:31], v[10:11]
  v_pk_fma_f32 v[86:87], v[86:87], s[30:31], v[10:11]
  v_pk_fma_f32 v[88:89], v[88:89], s[30:31], v[10:11]
  v_pk_fma_f32 v[90:91], v[90:91], s[30:31], v[10:11]
  v_pk_mul_f32 v[80:81], v[80:81], v[40:41]
  v_pk_mul_f32 v[82:83], v[82:83], v[42:43]
  v_pk_mul_f32 v[84:85], v[84:85], v[44:45]
  v_pk_mul_f32 v[86:87], v[86:87], v[46:47]
  v_pk_mul_f32 v[88:89], v[88:89], v[48:49]
  v_pk_mul_f32 v[90:91], v[90:91], v[50:51]
  v_exp_f32 v80, v80
  v_exp_f32 v81, v81
  v_pk_mul_f32 v[40:41], v[40:41], v[52:53]
  v_exp_f32 v82, v82
  v_exp_f32 v83, v83
  v_pk_mul_f32 v[42:43], v[42:43], v[54:55]
  v_exp_f32 v84, v84
  v_exp_f32 v85, v85
  v_pk_mul_f32 v[44:45], v[44:45], v[56:57]
  v_exp_f32 v86, v86
  v_exp_f32 v87, v87
  v_pk_mul_f32 v[46:47], v[46:47], v[58:59]
  v_exp_f32 v88, v88
  v_exp_f32 v89, v89
  v_pk_mul_f32 v[48:49], v[48:49], v[60:61]
  v_exp_f32 v90, v90
  v_exp_f32 v91, v91
  v_pk_mul_f32 v[50:51], v[50:51], v[62:63]
  v_pk_add_f32 v[80:81], v[80:81], 1.0 op_sel_hi:[1,0]
  v_pk_add_f32 v[82:83], v[82:83], 1.0 op_sel_hi:[1,0]
  v_pk_add_f32 v[84:85], v[84:85], 1.0 op_sel_hi:[1,0]
  v_pk_add_f32 v[86:87], v[86:87], 1.0 op_sel_hi:[1,0]
  v_pk_add_f32 v[88:89], v[88:89], 1.0 op_sel_hi:[1,0]
  v_pk_add_f32 v[90:91], v[90:91], 1.0 op_sel_hi:[1,0]
  v_rcp_f32 v80, v80
  v_rcp_f32 v81, v81
  v_rcp_f32 v82, v82
  v_rcp_f32 v83, v83
  v_rcp_f32 v84, v84
  v_rcp_f32 v85, v85
  v_rcp_f32 v86, v86
  v_rcp_f32 v87, v87
  v_rcp_f32 v88, v88
  v_rcp_f32 v89, v89
  v_rcp_f32 v90, v90
  v_rcp_f32 v91, v91
  v_pk_mul_f32 v[40:41], v[40:41], v[80:81]
  v_pk_mul_f32 v[42:43], v[42:43], v[82:83]
  v_pk_mul_f32 v[44:45], v[44:45], v[84:85]
  v_pk_mul_f32 v[46:47], v[46:47], v[86:87]
  v_pk_mul_f32 v[48:49], v[48:49], v[88:89]
  v_pk_mul_f32 v[50:51], v[50:51], v[90:91]
  v_cvt_pk_bf16_f32 v98, v40, v41
  v_cvt_pk_bf16_f32 v99, v42, v43
  v_cvt_pk_bf16_f32 v102, v44, v45
  v_cvt_pk_bf16_f32 v103, v46, v47
  v_cvt_pk_bf16_f32 v106, v48, v49
  v_cvt_pk_bf16_f32 v107, v50, v51
  v_permlane16_swap_b32 v96, v98
  v_permlane16_swap_b32 v97, v99
  buffer_store_dwordx4 v[96:99], v7, s[12:15], s29 offen offset:0 sc1
  v_permlane16_swap_b32 v100, v102
  v_permlane16_swap_b32 v101, v103
  buffer_store_dwordx4 v[100:103], v7, s[12:15], s29 offen offset:512 sc1
  v_permlane16_swap_b32 v104, v106
  v_permlane16_swap_b32 v105, v107
  buffer_store_dwordx4 v[104:107], v7, s[12:15], s29 offen offset:1024 sc1
  s_lshl_b32 s30, s50, 3
  s_lshr_b32 s28, s51, 3
  s_lshl_b32 s28, s28, 2
  s_add_u32 s30, s30, s28
  s_add_u32 s30, s30, s27
  s_mul_i32 s29, s30, 49152
  s_lshl_b32 s28, s26, 10
  s_add_u32 s29, s29, s28
  s_add_u32 s29, s29, 16777216
  s_lshl_b32 s30, s30, 4
  s_and_b32 s24, s51, 7
  v_lshrrev_b32 v3, 2, v2
  v_mul_u32_u24 v3, 160, v3
  v_and_b32 v4, 3, v2
  v_lshl_add_u32 v3, v4, 3, v3
  s_mul_i32 s28, s26, 5120
  v_add_u32 v3, s28, v3
  v_add_u32 v4, 61440, v3
  v_add_u32 v5, 122880, v3
  v_lshlrev_b32 v6, 4, v2
  v_and_b32 v12, 15, v2
  v_lshrrev_b32 v13, 4, v2
  v_mul_u32_u24 v8, 1280, v12
  v_lshl_add_u32 v8, v13, 3, v8
  s_mul_i32 s23, s30, 1280
  s_mul_i32 s25, s24, 160
  s_add_u32 s23, s23, s25
  s_add_u32 s23, s23, 10485760
  v_lshlrev_b32 v15, 4, v13
  s_lshl_b32 s28, s25, 1
  s_add_u32 s28, s28, 12800
  s_lshl_b32 s21, s26, 6
  s_add_u32 s23, s23, s21
  s_lshl_b32 s21, s26, 7
  s_add_u32 s28, s28, s21
  s_waitcnt vmcnt(0)
  s_mov_b32 s41, s29
  s_mov_b32 s16, s60
  s_mov_b32 s17, s61
  s_mov_b32 s18, 2621440
  s_mov_b32 s19, 0x00020000
  s_barrier
  buffer_load_dwordx4 v[76:79], v6, s[12:15], s29 offen offset:0 sc1
  buffer_load_dwordx4 v[80:83], v6, s[12:15], s29 offen offset:2048 sc1
  s_add_u32 s29, s29, 4096
  buffer_load_dwordx4 v[84:87], v6, s[12:15], s29 offen offset:0 sc1
  buffer_load_dwordx4 v[88:91], v6, s[12:15], s29 offen offset:2048 sc1
  s_add_u32 s29, s29, 4096
  buffer_load_dwordx4 v[92:95], v6, s[12:15], s29 offen offset:0 sc1
  buffer_load_dwordx4 v[96:99], v6, s[12:15], s29 offen offset:2048 sc1
  s_add_u32 s29, s29, 4096
  buffer_load_dwordx4 v[100:103], v6, s[12:15], s29 offen offset:0 sc1
  buffer_load_dwordx4 v[104:107], v6, s[12:15], s29 offen offset:2048 sc1
  s_add_u32 s29, s29, 4096
  buffer_load_dwordx4 v[108:111], v6, s[12:15], s29 offen offset:0 sc1
  ds_read_b64_tr_b16 v[36:37], v3 offset:51200
  ds_read_b64_tr_b16 v[38:39], v3 offset:53760
  ds_read_b64_tr_b16 v[40:41], v3 offset:51232
  ds_read_b64_tr_b16 v[42:43], v3 offset:53792
  ds_read_b64_tr_b16 v[44:45], v3 offset:51264
  ds_read_b64_tr_b16 v[46:47], v3 offset:53824
  ds_read_b64_tr_b16 v[48:49], v3 offset:51296
  ds_read_b64_tr_b16 v[50:51], v3 offset:53856
  ds_read_b64_tr_b16 v[52:53], v3 offset:51328
  ds_read_b64_tr_b16 v[54:55], v3 offset:53888
  s_waitcnt vmcnt(8)
  v_max3_u32 v9, v76, v77, v78
  v_max_u32 v9, v9, v79
  v_cmp_eq_u32 vcc, -1, v9
  s_waitcnt lgkmcnt(0)
  s_cmp_lg_u64 vcc, 0
  s_cbranch_scc1 KM_hs0
KM_hr0:
  buffer_load_dwordx4 v[112:115], v6, s[12:15], s29 offen offset:2048 sc1
  s_add_u32 s29, s29, 4096
  v_mfma_f32_16x16x32_bf16 v[16:19], v[36:39], v[76:79], 0
  ds_read_b64_tr_b16 v[56:57], v4 offset:0
  ds_read_b64_tr_b16 v[58:59], v4 offset:2560
  v_mfma_f32_16x16x32_bf16 v[20:23], v[40:43], v[76:79], 0
  ds_read_b64_tr_b16 v[60:61], v4 offset:32
  ds_read_b64_tr_b16 v[62:63], v4 offset:2592
  v_mfma_f32_16x16x32_bf16 v[24:27], v[44:47], v[76:79], 0
  ds_read_b64_tr_b16 v[64:65], v4 offset:64
  ds_read_b64_tr_b16 v[66:67], v4 offset:2624
  v_mfma_f32_16x16x32_bf16 v[28:31], v[48:51], v[76:79], 0
  ds_read_b64_tr_b16 v[68:69], v4 offset:96
  ds_read_b64_tr_b16 v[70:71], v4 offset:2656
  v_mfma_f32_16x16x32_bf16 v[32:35], v[52:55], v[76:79], 0
  ds_read_b64_tr_b16 v[72:73], v4 offset:128
  ds_read_b64_tr_b16 v[74:75], v4 offset:2688
  s_waitcnt vmcnt(8)
  v_max3_u32 v9, v80, v81, v82
  v_max_u32 v9, v9, v83
  v_cmp_eq_u32 vcc, -1, v9
  s_waitcnt lgkmcnt(0)
  s_cmp_lg_u64 vcc, 0
  s_cbranch_scc1 KM_hs1
KM_hr1:
  buffer_load_dwordx4 v[76:79], v6, s[12:15], s29 offen offset:0 sc1
  v_mfma_f32_16x16x32_bf16 v[16:19], v[56:59], v[80:83], v[16:19]
  ds_read_b64_tr_b16 v[36:37], v5 offset:10240
  ds_read_b64_tr_b16 v[38:39], v5 offset:12800
  v_mfma_f32_16x16x32_bf16 v[20:23], v[60:63], v[80:83], v[20:23]
  ds_read_b64_tr_b16 v[40:41], v5 offset:10272
  ds_read_b64_tr_b16 v[42:43], v5 offset:12832
  v_mfma_f32_16x16x32_bf16 v[24:27], v[64:67], v[80:83], v[24:27]
  ds_read_b64_tr_b16 v[44:45], v5 offset:10304
  ds_read_b64_tr_b16 v[46:47], v5 offset:12864
  v_mfma_f32_16x16x32_bf16 v[28:31], v[68:71], v[80:83], v[28:31]
  ds_read_b64_tr_b16 v[48:49], v5 offset:10336
  ds_read_b64_tr_b16 v[50:51], v5 offset:12896
  v_mfma_f32_16x16x32_bf16 v[32:35], v[72:75], v[80:83], v[32:35]
  ds_read_b64_tr_b16 v[52:53], v5 offset:10368
  ds_read_b64_tr_b16 v[54:55], v5 offset:12928
  s_waitcnt vmcnt(8)
  v_max3_u32 v9, v84, v85, v86
  v_max_u32 v9, v9, v87
  v_cmp_eq_u32 vcc, -1, v9
  s_waitcnt lgkmcnt(0)
  s_cmp_lg_u64 vcc, 0
  s_cbranch_scc1 KM_hs2
KM_hr2:
  buffer_load_dwordx4 v[80:83], v6, s[12:15], s29 offen offset:2048 sc1
  s_add_u32 s29, s29, 4096
  v_mfma_f32_16x16x32_bf16 v[16:19], v[36:39], v[84:87], v[16:19]
  ds_read_b64_tr_b16 v[56:57], v4 offset:10240
  ds_read_b64_tr_b16 v[58:59], v4 offset:12800
  v_mfma_f32_16x16x32_bf16 v[20:23], v[40:43], v[84:87], v[20:23]
  ds_read_b64_tr_b16 v[60:61], v4 offset:10272
  ds_read_b64_tr_b16 v[62:63], v4 offset:12832
  v_mfma_f32_16x16x32_bf16 v[24:27], v[44:47], v[84:87], v[24:27]
  ds_read_b64_tr_b16 v[64:65], v4 offset:10304
  ds_read_b64_tr_b16 v[66:67], v4 offset:12864
  v_mfma_f32_16x16x32_bf16 v[28:31], v[48:51], v[84:87], v[28:31]
  ds_read_b64_tr_b16 v[68:69], v4 offset:10336
  ds_read_b64_tr_b16 v[70:71], v4 offset:12896
  v_mfma_f32_16x16x32_bf16 v[32:35], v[52:55], v[84:87], v[32:35]
  ds_read_b64_tr_b16 v[72:73], v4 offset:10368
  ds_read_b64_tr_b16 v[74:75], v4 offset:12928
  s_waitcnt vmcnt(8)
  v_max3_u32 v9, v88, v89, v90
  v_max_u32 v9, v9, v91
  v_cmp_eq_u32 vcc, -1, v9
  s_waitcnt lgkmcnt(0)
  s_cmp_lg_u64 vcc, 0
  s_cbranch_scc1 KM_hs3
KM_hr3:
  s_barrier
  buffer_load_dwordx4 v[84:87], v6, s[12:15], s29 offen offset:0 sc1
  v_mfma_f32_16x16x32_bf16 v[16:19], v[56:59], v[88:91], v[16:19]
  ds_read_b64_tr_b16 v[36:37], v4 offset:20480
  ds_read_b64_tr_b16 v[38:39], v4 offset:23040
  v_mfma_f32_16x16x32_bf16 v[20:23], v[60:63], v[88:91], v[20:23]
  ds_read_b64_tr_b16 v[40:41], v4 offset:20512
  ds_read_b64_tr_b16 v[42:43], v4 offset:23072
  v_mfma_f32_16x16x32_bf16 v[24:27], v[64:67], v[88:91], v[24:27]
  ds_read_b64_tr_b16 v[44:45], v4 offset:20544
  ds_read_b64_tr_b16 v[46:47], v4 offset:23104
  v_mfma_f32_16x16x32_bf16 v[28:31], v[68:71], v[88:91], v[28:31]
  ds_read_b64_tr_b16 v[48:49], v4 offset:20576
  ds_read_b64_tr_b16 v[50:51], v4 offset:23136
  v_mfma_f32_16x16x32_bf16 v[32:35], v[72:75], v[88:91], v[32:35]
  ds_read_b64_tr_b16 v[52:53], v4 offset:20608
  ds_read_b64_tr_b16 v[54:55], v4 offset:23168
  s_waitcnt vmcnt(8)
  v_max3_u32 v9, v92, v93, v94
  v_max_u32 v9, v9, v95
  v_cmp_eq_u32 vcc, -1, v9
  s_waitcnt lgkmcnt(0)
  s_cmp_lg_u64 vcc, 0
  s_cbranch_scc1 KM_hs4
KM_hr4:
  buffer_load_dwordx4 v[88:91], v6, s[12:15], s29 offen offset:2048 sc1
  s_add_u32 s29, s29, 4096
  v_mfma_f32_16x16x32_bf16 v[16:19], v[36:39], v[92:95], v[16:19]
  ds_read_b64_tr_b16 v[56:57], v5 offset:20480
  ds_read_b64_tr_b16 v[58:59], v5 offset:23040
  v_mfma_f32_16x16x32_bf16 v[20:23], v[40:43], v[92:95], v[20:23]
  ds_read_b64_tr_b16 v[60:61], v5 offset:20512
  ds_read_b64_tr_b16 v[62:63], v5 offset:23072
  v_mfma_f32_16x16x32_bf16 v[24:27], v[44:47], v[92:95], v[24:27]
  ds_read_b64_tr_b16 v[64:65], v5 offset:20544
  ds_read_b64_tr_b16 v[66:67], v5 offset:23104
  v_mfma_f32_16x16x32_bf16 v[28:31], v[48:51], v[92:95], v[28:31]
  ds_read_b64_tr_b16 v[68:69], v5 offset:20576
  ds_read_b64_tr_b16 v[70:71], v5 offset:23136
  v_mfma_f32_16x16x32_bf16 v[32:35], v[52:55], v[92:95], v[32:35]
  ds_read_b64_tr_b16 v[72:73], v5 offset:20608
  ds_read_b64_tr_b16 v[74:75], v5 offset:23168
  s_waitcnt vmcnt(8)
  v_max3_u32 v9, v96, v97, v98
  v_max_u32 v9, v9, v99
  v_cmp_eq_u32 vcc, -1, v9
  s_waitcnt lgkmcnt(0)
  s_cmp_lg_u64 vcc, 0
  s_cbranch_scc1 KM_hs5
KM_hr5:
  buffer_load_dwordx4 v[92:95], v6, s[12:15], s29 offen offset:0 sc1
  v_mfma_f32_16x16x32_bf16 v[16:19], v[56:59], v[96:99], v[16:19]
  ds_read_b64_tr_b16 v[36:37], v5 offset:30720
  ds_read_b64_tr_b16 v[38:39], v5 offset:33280
  v_mfma_f32_16x16x32_bf16 v[20:23], v[60:63], v[96:99], v[20:23]
  ds_read_b64_tr_b16 v[40:41], v5 offset:30752
  ds_read_b64_tr_b16 v[42:43], v5 offset:33312
  v_mfma_f32_16x16x32_bf16 v[24:27], v[64:67], v[96:99], v[24:27]
  ds_read_b64_tr_b16 v[44:45], v5 offset:30784
  ds_read_b64_tr_b16 v[46:47], v5 offset:33344
  v_mfma_f32_16x16x32_bf16 v[28:31], v[68:71], v[96:99], v[28:31]
  ds_read_b64_tr_b16 v[48:49], v5 offset:30816
  ds_read_b64_tr_b16 v[50:51], v5 offset:33376
  v_mfma_f32_16x16x32_bf16 v[32:35], v[72:75], v[96:99], v[32:35]
  ds_read_b64_tr_b16 v[52:53], v5 offset:30848
  ds_read_b64_tr_b16 v[54:55], v5 offset:33408
  s_waitcnt vmcnt(8)
  v_max3_u32 v9, v100, v101, v102
  v_max_u32 v9, v9, v103
  v_cmp_eq_u32 vcc, -1, v9
  s_waitcnt lgkmcnt(0)
  s_cmp_lg_u64 vcc, 0
  s_cbranch_scc1 KM_hs6
KM_hr6:
  buffer_load_dwordx4 v[96:99], v6, s[12:15], s29 offen offset:2048 sc1
  s_add_u32 s29, s29, 4096
  v_mfma_f32_16x16x32_bf16 v[16:19], v[36:39], v[100:103], v[16:19]
  ds_read_b64_tr_b16 v[56:57], v3 offset:0
  ds_read_b64_tr_b16 v[58:59], v3 offset:2560
  v_mfma_f32_16x16x32_bf16 v[20:23], v[40:43], v[100:103], v[20:23]
  ds_read_b64_tr_b16 v[60:61], v3 offset:32
  ds_read_b64_tr_b16 v[62:63], v3 offset:2592
  v_mfma_f32_16x16x32_bf16 v[24:27], v[44:47], v[100:103], v[24:27]
  ds_read_b64_tr_b16 v[64:65], v3 offset:64
  ds_read_b64_tr_b16 v[66:67], v3 offset:2624
  v_mfma_f32_16x16x32_bf16 v[28:31], v[48:51], v[100:103], v[28:31]
  ds_read_b64_tr_b16 v[68:69], v3 offset:96
  ds_read_b64_tr_b16 v[70:71], v3 offset:2656
  v_mfma_f32_16x16x32_bf16 v[32:35], v[52:55], v[100:103], v[32:35]
  ds_read_b64_tr_b16 v[72:73], v3 offset:128
  ds_read_b64_tr_b16 v[74:75], v3 offset:2688
  s_waitcnt vmcnt(8)
  v_max3_u32 v9, v104, v105, v106
  v_max_u32 v9, v9, v107
  v_cmp_eq_u32 vcc, -1, v9
  s_waitcnt lgkmcnt(0)
  s_cmp_lg_u64 vcc, 0
  s_cbranch_scc1 KM_hs7
KM_hr7:
  s_barrier
  buffer_load_dwordx4 v[100:103], v6, s[12:15], s29 offen offset:0 sc1
  v_mfma_f32_16x16x32_bf16 v[16:19], v[56:59], v[104:107], v[16:19]
  ds_read_b64_tr_b16 v[36:37], v3 offset:10240
  ds_read_b64_tr_b16 v[38:39], v3 offset:12800
  v_mfma_f32_16x16x32_bf16 v[20:23], v[60:63], v[104:107], v[20:23]
  ds_read_b64_tr_b16 v[40:41], v3 offset:10272
  ds_read_b64_tr_b16 v[42:43], v3 offset:12832
  v_mfma_f32_16x16x32_bf16 v[24:27], v[64:67], v[104:107], v[24:27]
  ds_read_b64_tr_b16 v[44:45], v3 offset:10304
  ds_read_b64_tr_b16 v[46:47], v3 offset:12864
  v_mfma_f32_16x16x32_bf16 v[28:31], v[68:71], v[104:107], v[28:31]
  ds_read_b64_tr_b16 v[48:49], v3 offset:10336
  ds_read_b64_tr_b16 v[50:51], v3 offset:12896
  v_mfma_f32_16x16x32_bf16 v[32:35], v[72:75], v[104:107], v[32:35]
  ds_read_b64_tr_b16 v[52:53], v3 offset:10368
  ds_read_b64_tr_b16 v[54:55], v3 offset:12928
  s_waitcnt vmcnt(8)
  v_max3_u32 v9, v108, v109, v110
  v_max_u32 v9, v9, v111
  v_cmp_eq_u32 vcc, -1, v9
  s_waitcnt lgkmcnt(0)
  s_cmp_lg_u64 vcc, 0
  s_cbranch_scc1 KM_hs8
KM_hr8:
  buffer_load_dwordx4 v[104:107], v6, s[12:15], s29 offen offset:2048 sc1
  s_add_u32 s29, s29, 4096
  v_mfma_f32_16x16x32_bf16 v[16:19], v[36:39], v[108:111], v[16:19]
  ds_read_b64_tr_b16 v[56:57], v4 offset:30720
  ds_read_b64_tr_b16 v[58:59], v4 offset:33280
  v_mfma_f32_16x16x32_bf16 v[20:23], v[40:43], v[108:111], v[20:23]
  ds_read_b64_tr_b16 v[60:61], v4 offset:30752
  ds_read_b64_tr_b16 v[62:63], v4 offset:33312
  v_mfma_f32_16x16x32_bf16 v[24:27], v[44:47], v[108:111], v[24:27]
  ds_read_b64_tr_b16 v[64:65], v4 offset:30784
  ds_read_b64_tr_b16 v[66:67], v4 offset:33344
  v_mfma_f32_16x16x32_bf16 v[28:31], v[48:51], v[108:111], v[28:31]
  ds_read_b64_tr_b16 v[68:69], v4 offset:30816
  ds_read_b64_tr_b16 v[70:71], v4 offset:33376
  v_mfma_f32_16x16x32_bf16 v[32:35], v[52:55], v[108:111], v[32:35]
  ds_read_b64_tr_b16 v[72:73], v4 offset:30848
  ds_read_b64_tr_b16 v[74:75], v4 offset:33408
  s_waitcnt vmcnt(8)
  v_max3_u32 v9, v112, v113, v114
  v_max_u32 v9, v9, v115
  v_cmp_eq_u32 vcc, -1, v9
  s_waitcnt lgkmcnt(0)
  s_cmp_lg_u64 vcc, 0
  s_cbranch_scc1 KM_hs9
KM_hr9:
  buffer_load_dwordx4 v[108:111], v6, s[12:15], s29 offen offset:0 sc1
  v_mfma_f32_16x16x32_bf16 v[16:19], v[56:59], v[112:115], v[16:19]
  ds_read_b64_tr_b16 v[36:37], v4 offset:40960
  ds_read_b64_tr_b16 v[38:39], v4 offset:43520
  v_mfma_f32_16x16x32_bf16 v[20:23], v[60:63], v[112:115], v[20:23]
  ds_read_b64_tr_b16 v[40:41], v4 offset:40992
  ds_read_b64_tr_b16 v[42:43], v4 offset:43552
  v_mfma_f32_16x16x32_bf16 v[24:27], v[64:67], v[112:115], v[24:27]
  ds_read_b64_tr_b16 v[44:45], v4 offset:41024
  ds_read_b64_tr_b16 v[46:47], v4 offset:43584
  v_mfma_f32_16x16x32_bf16 v[28:31], v[68:71], v[112:115], v[28:31]
  ds_read_b64_tr_b16 v[48:49], v4 offset:41056
  ds_read_b64_tr_b16 v[50:51], v4 offset:43616
  v_mfma_f32_16x16x32_bf16 v[32:35], v[72:75], v[112:115], v[32:35]
  ds_read_b64_tr_b16 v[52:53], v4 offset:41088
  ds_read_b64_tr_b16 v[54:55], v4 offset:43648
  s_waitcnt vmcnt(8)
  v_max3_u32 v9, v76, v77, v78
  v_max_u32 v9, v9, v79
  v_cmp_eq_u32 vcc, -1, v9
  s_waitcnt lgkmcnt(0)
  s_cmp_lg_u64 vcc, 0
  s_cbranch_scc1 KM_hs10
KM_hr10:
  buffer_load_dwordx4 v[112:115], v6, s[12:15], s29 offen offset:2048 sc1
  s_add_u32 s29, s29, 4096
  v_mfma_f32_16x16x32_bf16 v[16:19], v[36:39], v[76:79], v[16:19]
  ds_read_b64_tr_b16 v[56:57], v3 offset:20480
  ds_read_b64_tr_b16 v[58:59], v3 offset:23040
  v_mfma_f32_16x16x32_bf16 v[20:23], v[40:43], v[76:79], v[20:23]
  ds_read_b64_tr_b16 v[60:61], v3 offset:20512
  ds_read_b64_tr_b16 v[62:63], v3 offset:23072
  v_mfma_f32_16x16x32_bf16 v[24:27], v[44:47], v[76:79], v[24:27]
  ds_read_b64_tr_b16 v[64:65], v3 offset:20544
  ds_read_b64_tr_b16 v[66:67], v3 offset:23104
  v_mfma_f32_16x16x32_bf16 v[28:31], v[48:51], v[76:79], v[28:31]
  ds_read_b64_tr_b16 v[68:69], v3 offset:20576
  ds_read_b64_tr_b16 v[70:71], v3 offset:23136
  v_mfma_f32_16x16x32_bf16 v[32:35], v[52:55], v[76:79], v[32:35]
  ds_read_b64_tr_b16 v[72:73], v3 offset:20608
  ds_read_b64_tr_b16 v[74:75], v3 offset:23168
  s_waitcnt vmcnt(8)
  v_max3_u32 v9, v80, v81, v82
  v_max_u32 v9, v9, v83
  v_cmp_eq_u32 vcc, -1, v9
  s_waitcnt lgkmcnt(0)
  s_cmp_lg_u64 vcc, 0
  s_cbranch_scc1 KM_hs11
KM_hr11:
  buffer_load_dwordx4 v[76:79], v6, s[12:15], s29 offen offset:0 sc1
  v_mfma_f32_16x16x32_bf16 v[16:19], v[56:59], v[80:83], v[16:19]
  ds_read_b64_tr_b16 v[36:37], v3 offset:30720
  ds_read_b64_tr_b16 v[38:39], v3 offset:33280
  v_mfma_f32_16x16x32_bf16 v[20:23], v[60:63], v[80:83], v[20:23]
  ds_read_b64_tr_b16 v[40:41], v3 offset:30752
  ds_read_b64_tr_b16 v[42:43], v3 offset:33312
  v_mfma_f32_16x16x32_bf16 v[24:27], v[64:67], v[80:83], v[24:27]
  ds_read_b64_tr_b16 v[44:45], v3 offset:30784
  ds_read_b64_tr_b16 v[46:47], v3 offset:33344
  v_mfma_f32_16x16x32_bf16 v[28:31], v[68:71], v[80:83], v[28:31]
  ds_read_b64_tr_b16 v[48:49], v3 offset:30816
  ds_read_b64_tr_b16 v[50:51], v3 offset:33376
  v_mfma_f32_16x16x32_bf16 v[32:35], v[72:75], v[80:83], v[32:35]
  ds_read_b64_tr_b16 v[52:53], v3 offset:30848
  ds_read_b64_tr_b16 v[54:55], v3 offset:33408
  s_waitcnt vmcnt(8)
  v_max3_u32 v9, v84, v85, v86
  v_max_u32 v9, v9, v87
  v_cmp_eq_u32 vcc, -1, v9
  s_waitcnt lgkmcnt(0)
  s_cmp_lg_u64 vcc, 0
  s_cbranch_scc1 KM_hs12
KM_hr12:
  buffer_load_dwordx4 v[80:83], v6, s[12:15], s29 offen offset:2048 sc1
  s_add_u32 s29, s29, 4096
  v_mfma_f32_16x16x32_bf16 v[16:19], v[36:39], v[84:87], v[16:19]
  ds_read_b64_tr_b16 v[56:57], v3 offset:40960
  ds_read_b64_tr_b16 v[58:59], v3 offset:43520
  v_mfma_f32_16x16x32_bf16 v[20:23], v[40:43], v[84:87], v[20:23]
  ds_read_b64_tr_b16 v[60:61], v3 offset:40992
  ds_read_b64_tr_b16 v[62:63], v3 offset:43552
  v_mfma_f32_16x16x32_bf16 v[24:27], v[44:47], v[84:87], v[24:27]
  ds_read_b64_tr_b16 v[64:65], v3 offset:41024
  ds_read_b64_tr_b16 v[66:67], v3 offset:43584
  v_mfma_f32_16x16x32_bf16 v[28:31], v[48:51], v[84:87], v[28:31]
  ds_read_b64_tr_b16 v[68:69], v3 offset:41056
  ds_read_b64_tr_b16 v[70:71], v3 offset:43616
  v_mfma_f32_16x16x32_bf16 v[32:35], v[52:55], v[84:87], v[32:35]
  ds_read_b64_tr_b16 v[72:73], v3 offset:41088
  ds_read_b64_tr_b16 v[74:75], v3 offset:43648
  s_waitcnt vmcnt(8)
  v_max3_u32 v9, v88, v89, v90
  v_max_u32 v9, v9, v91
  v_cmp_eq_u32 vcc, -1, v9
  s_waitcnt lgkmcnt(0)
  s_cmp_lg_u64 vcc, 0
  s_cbranch_scc1 KM_hs13
KM_hr13:
  buffer_load_dwordx4 v[84:87], v6, s[12:15], s29 offen offset:0 sc1
  v_mfma_f32_16x16x32_bf16 v[16:19], v[56:59], v[88:91], v[16:19]
  ds_read_b64_tr_b16 v[36:37], v4 offset:51200
  ds_read_b64_tr_b16 v[38:39], v4 offset:53760
  v_mfma_f32_16x16x32_bf16 v[20:23], v[60:63], v[88:91], v[20:23]
  ds_read_b64_tr_b16 v[40:41], v4 offset:51232
  ds_read_b64_tr_b16 v[42:43], v4 offset:53792
  v_mfma_f32_16x16x32_bf16 v[24:27], v[64:67], v[88:91], v[24:27]
  ds_read_b64_tr_b16 v[44:45], v4 offset:51264
  ds_read_b64_tr_b16 v[46:47], v4 offset:53824
  v_mfma_f32_16x16x32_bf16 v[28:31], v[68:71], v[88:91], v[28:31]
  ds_read_b64_tr_b16 v[48:49], v4 offset:51296
  ds_read_b64_tr_b16 v[50:51], v4 offset:53856
  v_mfma_f32_16x16x32_bf16 v[32:35], v[72:75], v[88:91], v[32:35]
  ds_read_b64_tr_b16 v[52:53], v4 offset:51328
  ds_read_b64_tr_b16 v[54:55], v4 offset:53888
  s_waitcnt vmcnt(8)
  v_max3_u32 v9, v92, v93, v94
  v_max_u32 v9, v9, v95
  v_cmp_eq_u32 vcc, -1, v9
  s_waitcnt lgkmcnt(0)
  s_cmp_lg_u64 vcc, 0
  s_cbranch_scc1 KM_hs14
KM_hr14:
  buffer_load_dwordx4 v[88:91], v6, s[12:15], s29 offen offset:2048 sc1
  s_add_u32 s29, s29, 4096
  v_mfma_f32_16x16x32_bf16 v[16:19], v[36:39], v[92:95], v[16:19]
  ds_read_b64_tr_b16 v[56:57], v5 offset:0
  ds_read_b64_tr_b16 v[58:59], v5 offset:2560
  v_mfma_f32_16x16x32_bf16 v[20:23], v[40:43], v[92:95], v[20:23]
  ds_read_b64_tr_b16 v[60:61], v5 offset:32
  ds_read_b64_tr_b16 v[62:63], v5 offset:2592
  v_mfma_f32_16x16x32_bf16 v[24:27], v[44:47], v[92:95], v[24:27]
  ds_read_b64_tr_b16 v[64:65], v5 offset:64
  ds_read_b64_tr_b16 v[66:67], v5 offset:2624
  v_mfma_f32_16x16x32_bf16 v[28:31], v[48:51], v[92:95], v[28:31]
  ds_read_b64_tr_b16 v[68:69], v5 offset:96
  ds_read_b64_tr_b16 v[70:71], v5 offset:2656
  v_mfma_f32_16x16x32_bf16 v[32:35], v[52:55], v[92:95], v[32:35]
  ds_read_b64_tr_b16 v[72:73], v5 offset:128
  ds_read_b64_tr_b16 v[74:75], v5 offset:2688
  s_waitcnt vmcnt(8)
  v_max3_u32 v9, v96, v97, v98
  v_max_u32 v9, v9, v99
  v_cmp_eq_u32 vcc, -1, v9
  s_waitcnt lgkmcnt(0)
  s_cmp_lg_u64 vcc, 0
  s_cbranch_scc1 KM_hs15
KM_hr15:
  s_barrier
  buffer_load_dwordx2 v[116:117], v8, s[12:15], s23 offen offset:0 sc1
  buffer_load_dwordx4 v[128:131], v15, s[12:15], s28 offen offset:0 sc1
  v_mfma_f32_16x16x32_bf16 v[16:19], v[56:59], v[96:99], v[16:19]
  ds_read_b64_tr_b16 v[36:37], v3 offset:51200
  ds_read_b64_tr_b16 v[38:39], v3 offset:53760
  v_mfma_f32_16x16x32_bf16 v[20:23], v[60:63], v[96:99], v[20:23]
  ds_read_b64_tr_b16 v[40:41], v3 offset:51232
  ds_read_b64_tr_b16 v[42:43], v3 offset:53792
  v_mfma_f32_16x16x32_bf16 v[24:27], v[64:67], v[96:99], v[24:27]
  ds_read_b64_tr_b16 v[44:45], v3 offset:51264
  ds_read_b64_tr_b16 v[46:47], v3 offset:53824
  v_mfma_f32_16x16x32_bf16 v[28:31], v[68:71], v[96:99], v[28:31]
  ds_read_b64_tr_b16 v[48:49], v3 offset:51296
  ds_read_b64_tr_b16 v[50:51], v3 offset:53856
  v_mfma_f32_16x16x32_bf16 v[32:35], v[72:75], v[96:99], v[32:35]
  ds_read_b64_tr_b16 v[52:53], v3 offset:51328
  ds_read_b64_tr_b16 v[54:55], v3 offset:53888
  s_waitcnt vmcnt(9)
  v_max3_u32 v9, v100, v101, v102
  v_max_u32 v9, v9, v103
  v_cmp_eq_u32 vcc, -1, v9
  s_waitcnt lgkmcnt(0)
  s_cmp_lg_u64 vcc, 0
  s_cbranch_scc1 KM_hs16
KM_hr16:
  buffer_load_dwordx2 v[118:119], v8, s[12:15], s23 offen offset:32 sc1
  buffer_load_dwordx4 v[132:135], v15, s[12:15], s28 offen offset:64 sc1
  v_mfma_f32_16x16x32_bf16 v[16:19], v[36:39], v[100:103], v[16:19]
  ds_read_b64_tr_b16 v[56:57], v4 offset:0
  ds_read_b64_tr_b16 v[58:59], v4 offset:2560
  v_mfma_f32_16x16x32_bf16 v[20:23], v[40:43], v[100:103], v[20:23]
  ds_read_b64_tr_b16 v[60:61], v4 offset:32
  ds_read_b64_tr_b16 v[62:63], v4 offset:2592
  v_mfma_f32_16x16x32_bf16 v[24:27], v[44:47], v[100:103], v[24:27]
  ds_read_b64_tr_b16 v[64:65], v4 offset:64
  ds_read_b64_tr_b16 v[66:67], v4 offset:2624
  v_mfma_f32_16x16x32_bf16 v[28:31], v[48:51], v[100:103], v[28:31]
  ds_read_b64_tr_b16 v[68:69], v4 offset:96
  ds_read_b64_tr_b16 v[70:71], v4 offset:2656
  v_mfma_f32_16x16x32_bf16 v[32:35], v[52:55], v[100:103], v[32:35]
  ds_read_b64_tr_b16 v[72:73], v4 offset:128
  ds_read_b64_tr_b16 v[74:75], v4 offset:2688
  s_waitcnt vmcnt(10)
  v_max3_u32 v9, v104, v105, v106
  v_max_u32 v9, v9, v107
  v_cmp_eq_u32 vcc, -1, v9
  s_waitcnt lgkmcnt(0)
  s_cmp_lg_u64 vcc, 0
  s_cbranch_scc1 KM_hs17
KM_hr17:
  buffer_load_dwordx2 v[120:121], v8, s[12:15], s23 offen offset:64 sc1
  buffer_load_dwordx4 v[136:139], v15, s[12:15], s28 offen offset:128 sc1
  v_mfma_f32_16x16x32_bf16 v[16:19], v[56:59], v[104:107], v[16:19]
  ds_read_b64_tr_b16 v[36:37], v5 offset:10240
  ds_read_b64_tr_b16 v[38:39], v5 offset:12800
  v_mfma_f32_16x16x32_bf16 v[20:23], v[60:63], v[104:107], v[20:23]
  ds_read_b64_tr_b16 v[40:41], v5 offset:10272
  ds_read_b64_tr_b16 v[42:43], v5 offset:12832
  v_mfma_f32_16x16x32_bf16 v[24:27], v[64:67], v[104:107], v[24:27]
  ds_read_b64_tr_b16 v[44:45], v5 offset:10304
  ds_read_b64_tr_b16 v[46:47], v5 offset:12864
  v_mfma_f32_16x16x32_bf16 v[28:31], v[68:71], v[104:107], v[28:31]
  ds_read_b64_tr_b16 v[48:49], v5 offset:10336
  ds_read_b64_tr_b16 v[50:51], v5 offset:12896
  v_mfma_f32_16x16x32_bf16 v[32:35], v[72:75], v[104:107], v[32:35]
  ds_read_b64_tr_b16 v[52:53], v5 offset:10368
  ds_read_b64_tr_b16 v[54:55], v5 offset:12928
  s_waitcnt vmcnt(11)
  v_max3_u32 v9, v108, v109, v110
  v_max_u32 v9, v9, v111
  v_cmp_eq_u32 vcc, -1, v9
  s_waitcnt lgkmcnt(0)
  s_cmp_lg_u64 vcc, 0
  s_cbranch_scc1 KM_hs18
KM_hr18:
  v_mfma_f32_16x16x32_bf16 v[16:19], v[36:39], v[108:111], v[16:19]
  ds_read_b64_tr_b16 v[56:57], v4 offset:10240
  ds_read_b64_tr_b16 v[58:59], v4 offset:12800
  v_mfma_f32_16x16x32_bf16 v[20:23], v[40:43], v[108:111], v[20:23]
  ds_read_b64_tr_b16 v[60:61], v4 offset:10272
  ds_read_b64_tr_b16 v[62:63], v4 offset:12832
  v_mfma_f32_16x16x32_bf16 v[24:27], v[44:47], v[108:111], v[24:27]
  ds_read_b64_tr_b16 v[64:65], v4 offset:10304
  ds_read_b64_tr_b16 v[66:67], v4 offset:12864
  v_mfma_f32_16x16x32_bf16 v[28:31], v[48:51], v[108:111], v[28:31]
  ds_read_b64_tr_b16 v[68:69], v4 offset:10336
  ds_read_b64_tr_b16 v[70:71], v4 offset:12896
  v_mfma_f32_16x16x32_bf16 v[32:35], v[52:55], v[108:111], v[32:35]
  ds_read_b64_tr_b16 v[72:73], v4 offset:10368
  ds_read_b64_tr_b16 v[74:75], v4 offset:12928
  s_waitcnt vmcnt(10)
  v_max3_u32 v9, v112, v113, v114
  v_max_u32 v9, v9, v115
  v_cmp_eq_u32 vcc, -1, v9
  s_waitcnt lgkmcnt(0)
  s_cmp_lg_u64 vcc, 0
  s_cbranch_scc1 KM_hs19
KM_hr19:
  s_barrier
  v_mfma_f32_16x16x32_bf16 v[16:19], v[56:59], v[112:115], v[16:19]
  ds_read_b64_tr_b16 v[36:37], v4 offset:20480
  ds_read_b64_tr_b16 v[38:39], v4 offset:23040
  v_mfma_f32_16x16x32_bf16 v[20:23], v[60:63], v[112:115], v[20:23]
  ds_read_b64_tr_b16 v[40:41], v4 offset:20512
  ds_read_b64_tr_b16 v[42:43], v4 offset:23072
  v_mfma_f32_16x16x32_bf16 v[24:27], v[64:67], v[112:115], v[24:27]
  ds_read_b64_tr_b16 v[44:45], v4 offset:20544
  ds_read_b64_tr_b16 v[46:47], v4 offset:23104
  v_mfma_f32_16x16x32_bf16 v[28:31], v[68:71], v[112:115], v[28:31]
  ds_read_b64_tr_b16 v[48:49], v4 offset:20576
  ds_read_b64_tr_b16 v[50:51], v4 offset:23136
  v_mfma_f32_16x16x32_bf16 v[32:35], v[72:75], v[112:115], v[32:35]
  ds_read_b64_tr_b16 v[52:53], v4 offset:20608
  ds_read_b64_tr_b16 v[54:55], v4 offset:23168
  s_waitcnt vmcnt(9)
  v_max3_u32 v9, v76, v77, v78
  v_max_u32 v9, v9, v79
  v_cmp_eq_u32 vcc, -1, v9
  s_waitcnt lgkmcnt(0)
  s_cmp_lg_u64 vcc, 0
  s_cbranch_scc1 KM_hs20
KM_hr20:
  v_mfma_f32_16x16x32_bf16 v[16:19], v[36:39], v[76:79], v[16:19]
  ds_read_b64_tr_b16 v[56:57], v5 offset:20480
  ds_read_b64_tr_b16 v[58:59], v5 offset:23040
  v_mfma_f32_16x16x32_bf16 v[20:23], v[40:43], v[76:79], v[20:23]
  ds_read_b64_tr_b16 v[60:61], v5 offset:20512
  ds_read_b64_tr_b16 v[62:63], v5 offset:23072
  v_mfma_f32_16x16x32_bf16 v[24:27], v[44:47], v[76:79], v[24:27]
  ds_read_b64_tr_b16 v[64:65], v5 offset:20544
  ds_read_b64_tr_b16 v[66:67], v5 offset:23104
  v_mfma_f32_16x16x32_bf16 v[28:31], v[48:51], v[76:79], v[28:31]
  ds_read_b64_tr_b16 v[68:69], v5 offset:20576
  ds_read_b64_tr_b16 v[70:71], v5 offset:23136
  v_mfma_f32_16x16x32_bf16 v[32:35], v[52:55], v[76:79], v[32:35]
  ds_read_b64_tr_b16 v[72:73], v5 offset:20608
  ds_read_b64_tr_b16 v[74:75], v5 offset:23168
  s_waitcnt vmcnt(8)
  v_max3_u32 v9, v80, v81, v82
  v_max_u32 v9, v9, v83
  v_cmp_eq_u32 vcc, -1, v9
  s_waitcnt lgkmcnt(0)
  s_cmp_lg_u64 vcc, 0
  s_cbranch_scc1 KM_hs21
KM_hr21:
  v_mfma_f32_16x16x32_bf16 v[16:19], v[56:59], v[80:83], v[16:19]
  ds_read_b64_tr_b16 v[36:37], v5 offset:30720
  ds_read_b64_tr_b16 v[38:39], v5 offset:33280
  v_mfma_f32_16x16x32_bf16 v[20:23], v[60:63], v[80:83], v[20:23]
  ds_read_b64_tr_b16 v[40:41], v5 offset:30752
  ds_read_b64_tr_b16 v[42:43], v5 offset:33312
  v_mfma_f32_16x16x32_bf16 v[24:27], v[64:67], v[80:83], v[24:27]
  ds_read_b64_tr_b16 v[44:45], v5 offset:30784
  ds_read_b64_tr_b16 v[46:47], v5 offset:33344
  v_mfma_f32_16x16x32_bf16 v[28:31], v[68:71], v[80:83], v[28:31]
  ds_read_b64_tr_b16 v[48:49], v5 offset:30816
  ds_read_b64_tr_b16 v[50:51], v5 offset:33376
  v_mfma_f32_16x16x32_bf16 v[32:35], v[72:75], v[80:83], v[32:35]
  ds_read_b64_tr_b16 v[52:53], v5 offset:30848
  ds_read_b64_tr_b16 v[54:55], v5 offset:33408
  s_waitcnt vmcnt(7)
  v_max3_u32 v9, v84, v85, v86
  v_max_u32 v9, v9, v87
  v_cmp_eq_u32 vcc, -1, v9
  s_waitcnt lgkmcnt(0)
  s_cmp_lg_u64 vcc, 0
  s_cbranch_scc1 KM_hs22
KM_hr22:
  v_mfma_f32_16x16x32_bf16 v[16:19], v[36:39], v[84:87], v[16:19]
  ds_read_b64_tr_b16 v[56:57], v3 offset:0
  ds_read_b64_tr_b16 v[58:59], v3 offset:2560
  v_mfma_f32_16x16x32_bf16 v[20:23], v[40:43], v[84:87], v[20:23]
  ds_read_b64_tr_b16 v[60:61], v3 offset:32
  ds_read_b64_tr_b16 v[62:63], v3 offset:2592
  v_mfma_f32_16x16x32_bf16 v[24:27], v[44:47], v[84:87], v[24:27]
  ds_read_b64_tr_b16 v[64:65], v3 offset:64
  ds_read_b64_tr_b16 v[66:67], v3 offset:2624
  v_mfma_f32_16x16x32_bf16 v[28:31], v[48:51], v[84:87], v[28:31]
  ds_read_b64_tr_b16 v[68:69], v3 offset:96
  ds_read_b64_tr_b16 v[70:71], v3 offset:2656
  v_mfma_f32_16x16x32_bf16 v[32:35], v[52:55], v[84:87], v[32:35]
  ds_read_b64_tr_b16 v[72:73], v3 offset:128
  ds_read_b64_tr_b16 v[74:75], v3 offset:2688
  s_waitcnt vmcnt(6)
  v_max3_u32 v9, v88, v89, v90
  v_max_u32 v9, v9, v91
  v_cmp_eq_u32 vcc, -1, v9
  s_waitcnt lgkmcnt(0)
  s_cmp_lg_u64 vcc, 0
  s_cbranch_scc1 KM_hs23
KM_hr23:
  v_mfma_f32_16x16x32_bf16 v[16:19], v[56:59], v[88:91], v[16:19]
  v_mfma_f32_16x16x32_bf16 v[20:23], v[60:63], v[88:91], v[20:23]
  v_mfma_f32_16x16x32_bf16 v[24:27], v[64:67], v[88:91], v[24:27]
  v_mfma_f32_16x16x32_bf16 v[28:31], v[68:71], v[88:91], v[28:31]
  v_mfma_f32_16x16x32_bf16 v[32:35], v[72:75], v[88:91], v[32:35]
  s_mul_i32 s28, s27, 5120
  s_add_u32 s28, s28, 102400
  v_add_u32 v6, s28, v6
  s_and_b32 s23, s30, 63
  s_lshl_b32 s23, s23, 5
  s_lshr_b32 s29, s30, 6
  s_add_u32 s23, s23, s29
  s_mul_i32 s23, s23, 1280
  s_add_u32 s23, s23, s25
  v_mul_u32_u24 v8, 40960, v12
  v_lshl_add_u32 v8, v13, 3, v8
  s_cmp_eq_u32 s26, 0
  s_cbranch_scc1 KM_lo
  ds_write_b128 v6, v[16:19] offset:0
  ds_write_b128 v6, v[20:23] offset:1024
  ds_write_b128 v6, v[24:27] offset:2048
  s_waitcnt vmcnt(0)
  v_lshlrev_b32 v88, 16, v118
  v_and_b32 v89, 0xffff0000, v118
  v_lshlrev_b32 v90, 16, v119
  v_and_b32 v91, 0xffff0000, v119
  v_lshlrev_b32 v92, 16, v120
  v_and_b32 v93, 0xffff0000, v120
  v_lshlrev_b32 v94, 16, v121
  v_and_b32 v95, 0xffff0000, v121
  s_waitcnt lgkmcnt(0)
  s_barrier
  ds_read_b128 v[48:51], v6 offset:3072
  ds_read_b128 v[52:55], v6 offset:4096
  s_waitcnt lgkmcnt(1)
  v_pk_add_f32 v[28:29], v[28:29], v[48:49]
  v_pk_add_f32 v[30:31], v[30:31], v[50:51]
  v_pk_fma_f32 v[88:89], v[28:29], v[132:133], v[88:89]
  v_pk_fma_f32 v[90:91], v[30:31], v[134:135], v[90:91]
  v_cvt_pk_bf16_f32 v118, v88, v89
  v_cvt_pk_bf16_f32 v119, v90, v91
  buffer_store_dwordx2 v[118:119], v8, s[16:19], s23 offen offset:96
  s_waitcnt lgkmcnt(0)
  v_pk_add_f32 v[32:33], v[32:33], v[52:53]
  v_pk_add_f32 v[34:35], v[34:35], v[54:55]
  v_pk_fma_f32 v[92:93], v[32:33], v[136:137], v[92:93]
  v_pk_fma_f32 v[94:95], v[34:35], v[138:139], v[94:95]
  v_cvt_pk_bf16_f32 v120, v92, v93
  v_cvt_pk_bf16_f32 v121, v94, v95
  buffer_store_dwordx2 v[120:121], v8, s[16:19], s23 offen offset:128
  s_endpgm
KM_lo:
  ds_write_b128 v6, v[28:31] offset:3072
  ds_write_b128 v6, v[32:35] offset:4096
  s_waitcnt vmcnt(0)
  v_lshlrev_b32 v76, 16, v116
  v_and_b32 v77, 0xffff0000, v116
  v_lshlrev_b32 v78, 16, v117
  v_and_b32 v79, 0xffff0000, v117
  v_lshlrev_b32 v80, 16, v118
  v_and_b32 v81, 0xffff0000, v118
  v_lshlrev_b32 v82, 16, v119
  v_and_b32 v83, 0xffff0000, v119
  v_lshlrev_b32 v84, 16, v120
  v_and_b32 v85, 0xffff0000, v120
  v_lshlrev_b32 v86, 16, v121
  v_and_b32 v87, 0xffff0000, v121
  s_waitcnt lgkmcnt(0)
  s_barrier
  ds_read_b128 v[36:39], v6 offset:0
  ds_read_b128 v[40:43], v6 offset:1024
  ds_read_b128 v[44:47], v6 offset:2048
  s_waitcnt lgkmcnt(2)
  v_pk_add_f32 v[16:17], v[16:17], v[36:37]
  v_pk_add_f32 v[18:19], v[18:19], v[38:39]
  v_pk_fma_f32 v[76:77], v[16:17], v[128:129], v[76:77]
  v_pk_fma_f32 v[78:79], v[18:19], v[130:131], v[78:79]
  v_cvt_pk_bf16_f32 v116, v76, v77
  v_cvt_pk_bf16_f32 v117, v78, v79
  buffer_store_dwordx2 v[116:117], v8, s[16:19], s23 offen offset:0
  s_waitcnt lgkmcnt(1)
  v_pk_add_f32 v[20:21], v[20:21], v[40:41]
  v_pk_add_f32 v[22:23], v[22:23], v[42:43]
  v_pk_fma_f32 v[80:81], v[20:21], v[132:133], v[80:81]
  v_pk_fma_f32 v[82:83], v[22:23], v[134:135], v[82:83]
  v_cvt_pk_bf16_f32 v118, v80, v81
  v_cvt_pk_bf16_f32 v119, v82, v83
  buffer_store_dwordx2 v[118:119], v8, s[16:19], s23 offen offset:32
  s_waitcnt lgkmcnt(0)
  v_pk_add_f32 v[24:25], v[24:25], v[44:45]
  v_pk_add_f32 v[26:27], v[26:27], v[46:47]
  v_pk_fma_f32 v[84:85], v[24:25], v[136:137], v[84:85]
  v_pk_fma_f32 v[86:87], v[26:27], v[138:139], v[86:87]
  v_cvt_pk_bf16_f32 v120, v84, v85
  v_cvt_pk_bf16_f32 v121, v86, v87
  buffer_store_dwordx2 v[120:121], v8, s[16:19], s23 offen offset:64
  s_endpgm
KM_hs0:
  s_add_u32 s40, s41, 0
  s_mov_b32 s46, 0x8000
KM_hl0:
  s_mov_b64 exec, vcc
  s_sleep 2
  buffer_load_dwordx4 v[76:79], v6, s[12:15], s40 offen sc1
  s_waitcnt vmcnt(0)
  v_max3_u32 v9, v76, v77, v78
  v_max_u32 v9, v9, v79
  v_cmp_eq_u32 vcc, -1, v9
  s_mov_b64 exec, -1
  s_sub_u32 s46, s46, 1
  s_cmp_eq_u32 s46, 0
  s_cbranch_scc1 KM_hr0
  s_cmp_lg_u64 vcc, 0
  s_cbranch_scc1 KM_hl0
  s_branch KM_hr0
KM_hs1:
  s_add_u32 s40, s41, 2048
  s_mov_b32 s46, 0x8000
KM_hl1:
  s_mov_b64 exec, vcc
  s_sleep 2
  buffer_load_dwordx4 v[80:83], v6, s[12:15], s40 offen sc1
  s_waitcnt vmcnt(0)
  v_max3_u32 v9, v80, v81, v82
  v_max_u32 v9, v9, v83
  v_cmp_eq_u32 vcc, -1, v9
  s_mov_b64 exec, -1
  s_sub_u32 s46, s46, 1
  s_cmp_eq_u32 s46, 0
  s_cbranch_scc1 KM_hr1
  s_cmp_lg_u64 vcc, 0
  s_cbranch_scc1 KM_hl1
  s_branch KM_hr1
KM_hs2:
  s_add_u32 s40, s41, 4096
  s_mov_b32 s46, 0x8000
KM_hl2:
  s_mov_b64 exec, vcc
  s_sleep 2
  buffer_load_dwordx4 v[84:87], v6, s[12:15], s40 offen sc1
  s_waitcnt vmcnt(0)
  v_max3_u32 v9, v84, v85, v86
  v_max_u32 v9, v9, v87
  v_cmp_eq_u32 vcc, -1, v9
  s_mov_b64 exec, -1
  s_sub_u32 s46, s46, 1
  s_cmp_eq_u32 s46, 0
  s_cbranch_scc1 KM_hr2
  s_cmp_lg_u64 vcc, 0
  s_cbranch_scc1 KM_hl2
  s_branch KM_hr2
KM_hs3:
  s_add_u32 s40, s41, 6144
  s_mov_b32 s46, 0x8000
KM_hl3:
  s_mov_b64 exec, vcc
  s_sleep 2
  buffer_load_dwordx4 v[88:91], v6, s[12:15], s40 offen sc1
  s_waitcnt vmcnt(0)
  v_max3_u32 v9, v88, v89, v90
  v_max_u32 v9, v9, v91
  v_cmp_eq_u32 vcc, -1, v9
  s_mov_b64 exec, -1
  s_sub_u32 s46, s46, 1
  s_cmp_eq_u32 s46, 0
  s_cbranch_scc1 KM_hr3
  s_cmp_lg_u64 vcc, 0
  s_cbranch_scc1 KM_hl3
  s_branch KM_hr3
KM_hs4:
  s_add_u32 s40, s41, 8192
  s_mov_b32 s46, 0x8000
KM_hl4:
  s_mov_b64 exec, vcc
  s_sleep 2
  buffer_load_dwordx4 v[92:95], v6, s[12:15], s40 offen sc1
  s_waitcnt vmcnt(0)
  v_max3_u32 v9, v92, v93, v94
  v_max_u32 v9, v9, v95
  v_cmp_eq_u32 vcc, -1, v9
  s_mov_b64 exec, -1
  s_sub_u32 s46, s46, 1
  s_cmp_eq_u32 s46, 0
  s_cbranch_scc1 KM_hr4
  s_cmp_lg_u64 vcc, 0
  s_cbranch_scc1 KM_hl4
  s_branch KM_hr4
KM_hs5:
  s_add_u32 s40, s41, 10240
  s_mov_b32 s46, 0x8000
KM_hl5:
  s_mov_b64 exec, vcc
  s_sleep 2
  buffer_load_dwordx4 v[96:99], v6, s[12:15], s40 offen sc1
  s_waitcnt vmcnt(0)
  v_max3_u32 v9, v96, v97, v98
  v_max_u32 v9, v9, v99
  v_cmp_eq_u32 vcc, -1, v9
  s_mov_b64 exec, -1
  s_sub_u32 s46, s46, 1
  s_cmp_eq_u32 s46, 0
  s_cbranch_scc1 KM_hr5
  s_cmp_lg_u64 vcc, 0
  s_cbranch_scc1 KM_hl5
  s_branch KM_hr5
KM_hs6:
  s_add_u32 s40, s41, 12288
  s_mov_b32 s46, 0x8000
KM_hl6:
  s_mov_b64 exec, vcc
  s_sleep 2
  buffer_load_dwordx4 v[100:103], v6, s[12:15], s40 offen sc1
  s_waitcnt vmcnt(0)
  v_max3_u32 v9, v100, v101, v102
  v_max_u32 v9, v9, v103
  v_cmp_eq_u32 vcc, -1, v9
  s_mov_b64 exec, -1
  s_sub_u32 s46, s46, 1
  s_cmp_eq_u32 s46, 0
  s_cbranch_scc1 KM_hr6
  s_cmp_lg_u64 vcc, 0
  s_cbranch_scc1 KM_hl6
  s_branch KM_hr6
KM_hs7:
  s_add_u32 s40, s41, 14336
  s_mov_b32 s46, 0x8000
KM_hl7:
  s_mov_b64 exec, vcc
  s_sleep 2
  buffer_load_dwordx4 v[104:107], v6, s[12:15], s40 offen sc1
  s_waitcnt vmcnt(0)
  v_max3_u32 v9, v104, v105, v106
  v_max_u32 v9, v9, v107
  v_cmp_eq_u32 vcc, -1, v9
  s_mov_b64 exec, -1
  s_sub_u32 s46, s46, 1
  s_cmp_eq_u32 s46, 0
  s_cbranch_scc1 KM_hr7
  s_cmp_lg_u64 vcc, 0
  s_cbranch_scc1 KM_hl7
  s_branch KM_hr7
KM_hs8:
  s_add_u32 s40, s41, 16384
  s_mov_b32 s46, 0x8000
KM_hl8:
  s_mov_b64 exec, vcc
  s_sleep 2
  buffer_load_dwordx4 v[108:111], v6, s[12:15], s40 offen sc1
  s_waitcnt vmcnt(0)
  v_max3_u32 v9, v108, v109, v110
  v_max_u32 v9, v9, v111
  v_cmp_eq_u32 vcc, -1, v9
  s_mov_b64 exec, -1
  s_sub_u32 s46, s46, 1
  s_cmp_eq_u32 s46, 0
  s_cbranch_scc1 KM_hr8
  s_cmp_lg_u64 vcc, 0
  s_cbranch_scc1 KM_hl8
  s_branch KM_hr8
KM_hs9:
  s_add_u32 s40, s41, 18432
  s_mov_b32 s46, 0x8000
KM_hl9:
  s_mov_b64 exec, vcc
  s_sleep 2
  buffer_load_dwordx4 v[112:115], v6, s[12:15], s40 offen sc1
  s_waitcnt vmcnt(0)
  v_max3_u32 v9, v112, v113, v114
  v_max_u32 v9, v9, v115
  v_cmp_eq_u32 vcc, -1, v9
  s_mov_b64 exec, -1
  s_sub_u32 s46, s46, 1
  s_cmp_eq_u32 s46, 0
  s_cbranch_scc1 KM_hr9
  s_cmp_lg_u64 vcc, 0
  s_cbranch_scc1 KM_hl9
  s_branch KM_hr9
KM_hs10:
  s_add_u32 s40, s41, 20480
  s_mov_b32 s46, 0x8000
KM_hl10:
  s_mov_b64 exec, vcc
  s_sleep 2
  buffer_load_dwordx4 v[76:79], v6, s[12:15], s40 offen sc1
  s_waitcnt vmcnt(0)
  v_max3_u32 v9, v76, v77, v78
  v_max_u32 v9, v9, v79
  v_cmp_eq_u32 vcc, -1, v9
  s_mov_b64 exec, -1
  s_sub_u32 s46, s46, 1
  s_cmp_eq_u32 s46, 0
  s_cbranch_scc1 KM_hr10
  s_cmp_lg_u64 vcc, 0
  s_cbranch_scc1 KM_hl10
  s_branch KM_hr10
KM_hs11:
  s_add_u32 s40, s41, 22528
  s_mov_b32 s46, 0x8000
KM_hl11:
  s_mov_b64 exec, vcc
  s_sleep 2
  buffer_load_dwordx4 v[80:83], v6, s[12:15], s40 offen sc1
  s_waitcnt vmcnt(0)
  v_max3_u32 v9, v80, v81, v82
  v_max_u32 v9, v9, v83
  v_cmp_eq_u32 vcc, -1, v9
  s_mov_b64 exec, -1
  s_sub_u32 s46, s46, 1
  s_cmp_eq_u32 s46, 0
  s_cbranch_scc1 KM_hr11
  s_cmp_lg_u64 vcc, 0
  s_cbranch_scc1 KM_hl11
  s_branch KM_hr11
KM_hs12:
  s_add_u32 s40, s41, 24576
  s_mov_b32 s46, 0x8000
KM_hl12:
  s_mov_b64 exec, vcc
  s_sleep 2
  buffer_load_dwordx4 v[84:87], v6, s[12:15], s40 offen sc1
  s_waitcnt vmcnt(0)
  v_max3_u32 v9, v84, v85, v86
  v_max_u32 v9, v9, v87
  v_cmp_eq_u32 vcc, -1, v9
  s_mov_b64 exec, -1
  s_sub_u32 s46, s46, 1
  s_cmp_eq_u32 s46, 0
  s_cbranch_scc1 KM_hr12
  s_cmp_lg_u64 vcc, 0
  s_cbranch_scc1 KM_hl12
  s_branch KM_hr12
KM_hs13:
  s_add_u32 s40, s41, 26624
  s_mov_b32 s46, 0x8000
KM_hl13:
  s_mov_b64 exec, vcc
  s_sleep 2
  buffer_load_dwordx4 v[88:91], v6, s[12:15], s40 offen sc1
  s_waitcnt vmcnt(0)
  v_max3_u32 v9, v88, v89, v90
  v_max_u32 v9, v9, v91
  v_cmp_eq_u32 vcc, -1, v9
  s_mov_b64 exec, -1
  s_sub_u32 s46, s46, 1
  s_cmp_eq_u32 s46, 0
  s_cbranch_scc1 KM_hr13
  s_cmp_lg_u64 vcc, 0
  s_cbranch_scc1 KM_hl13
  s_branch KM_hr13
KM_hs14:
  s_add_u32 s40, s41, 28672
  s_mov_b32 s46, 0x8000
KM_hl14:
  s_mov_b64 exec, vcc
  s_sleep 2
  buffer_load_dwordx4 v[92:95], v6, s[12:15], s40 offen sc1
  s_waitcnt vmcnt(0)
  v_max3_u32 v9, v92, v93, v94
  v_max_u32 v9, v9, v95
  v_cmp_eq_u32 vcc, -1, v9
  s_mov_b64 exec, -1
  s_sub_u32 s46, s46, 1
  s_cmp_eq_u32 s46, 0
  s_cbranch_scc1 KM_hr14
  s_cmp_lg_u64 vcc, 0
  s_cbranch_scc1 KM_hl14
  s_branch KM_hr14
KM_hs15:
  s_add_u32 s40, s41, 30720
  s_mov_b32 s46, 0x8000
KM_hl15:
  s_mov_b64 exec, vcc
  s_sleep 2
  buffer_load_dwordx4 v[96:99], v6, s[12:15], s40 offen sc1
  s_waitcnt vmcnt(0)
  v_max3_u32 v9, v96, v97, v98
  v_max_u32 v9, v9, v99
  v_cmp_eq_u32 vcc, -1, v9
  s_mov_b64 exec, -1
  s_sub_u32 s46, s46, 1
  s_cmp_eq_u32 s46, 0
  s_cbranch_scc1 KM_hr15
  s_cmp_lg_u64 vcc, 0
  s_cbranch_scc1 KM_hl15
  s_branch KM_hr15
KM_hs16:
  s_add_u32 s40, s41, 32768
  s_mov_b32 s46, 0x8000
KM_hl16:
  s_mov_b64 exec, vcc
  s_sleep 2
  buffer_load_dwordx4 v[100:103], v6, s[12:15], s40 offen sc1
  s_waitcnt vmcnt(0)
  v_max3_u32 v9, v100, v101, v102
  v_max_u32 v9, v9, v103
  v_cmp_eq_u32 vcc, -1, v9
  s_mov_b64 exec, -1
  s_sub_u32 s46, s46, 1
  s_cmp_eq_u32 s46, 0
  s_cbranch_scc1 KM_hr16
  s_cmp_lg_u64 vcc, 0
  s_cbranch_scc1 KM_hl16
  s_branch KM_hr16
KM_hs17:
  s_add_u32 s40, s41, 34816
  s_mov_b32 s46, 0x8000
KM_hl17:
  s_mov_b64 exec, vcc
  s_sleep 2
  buffer_load_dwordx4 v[104:107], v6, s[12:15], s40 offen sc1
  s_waitcnt vmcnt(0)
  v_max3_u32 v9, v104, v105, v106
  v_max_u32 v9, v9, v107
  v_cmp_eq_u32 vcc, -1, v9
  s_mov_b64 exec, -1
  s_sub_u32 s46, s46, 1
  s_cmp_eq_u32 s46, 0
  s_cbranch_scc1 KM_hr17
  s_cmp_lg_u64 vcc, 0
  s_cbranch_scc1 KM_hl17
  s_branch KM_hr17
KM_hs18:
  s_add_u32 s40, s41, 36864
  s_mov_b32 s46, 0x8000
KM_hl18:
  s_mov_b64 exec, vcc
  s_sleep 2
  buffer_load_dwordx4 v[108:111], v6, s[12:15], s40 offen sc1
  s_waitcnt vmcnt(0)
  v_max3_u32 v9, v108, v109, v110
  v_max_u32 v9, v9, v111
  v_cmp_eq_u32 vcc, -1, v9
  s_mov_b64 exec, -1
  s_sub_u32 s46, s46, 1
  s_cmp_eq_u32 s46, 0
  s_cbranch_scc1 KM_hr18
  s_cmp_lg_u64 vcc, 0
  s_cbranch_scc1 KM_hl18
  s_branch KM_hr18
KM_hs19:
  s_add_u32 s40, s41, 38912
  s_mov_b32 s46, 0x8000
KM_hl19:
  s_mov_b64 exec, vcc
  s_sleep 2
  buffer_load_dwordx4 v[112:115], v6, s[12:15], s40 offen sc1
  s_waitcnt vmcnt(0)
  v_max3_u32 v9, v112, v113, v114
  v_max_u32 v9, v9, v115
  v_cmp_eq_u32 vcc, -1, v9
  s_mov_b64 exec, -1
  s_sub_u32 s46, s46, 1
  s_cmp_eq_u32 s46, 0
  s_cbranch_scc1 KM_hr19
  s_cmp_lg_u64 vcc, 0
  s_cbranch_scc1 KM_hl19
  s_branch KM_hr19
KM_hs20:
  s_add_u32 s40, s41, 40960
  s_mov_b32 s46, 0x8000
KM_hl20:
  s_mov_b64 exec, vcc
  s_sleep 2
  buffer_load_dwordx4 v[76:79], v6, s[12:15], s40 offen sc1
  s_waitcnt vmcnt(0)
  v_max3_u32 v9, v76, v77, v78
  v_max_u32 v9, v9, v79
  v_cmp_eq_u32 vcc, -1, v9
  s_mov_b64 exec, -1
  s_sub_u32 s46, s46, 1
  s_cmp_eq_u32 s46, 0
  s_cbranch_scc1 KM_hr20
  s_cmp_lg_u64 vcc, 0
  s_cbranch_scc1 KM_hl20
  s_branch KM_hr20
KM_hs21:
  s_add_u32 s40, s41, 43008
  s_mov_b32 s46, 0x8000
KM_hl21:
  s_mov_b64 exec, vcc
  s_sleep 2
  buffer_load_dwordx4 v[80:83], v6, s[12:15], s40 offen sc1
  s_waitcnt vmcnt(0)
  v_max3_u32 v9, v80, v81, v82
  v_max_u32 v9, v9, v83
  v_cmp_eq_u32 vcc, -1, v9
  s_mov_b64 exec, -1
  s_sub_u32 s46, s46, 1
  s_cmp_eq_u32 s46, 0
  s_cbranch_scc1 KM_hr21
  s_cmp_lg_u64 vcc, 0
  s_cbranch_scc1 KM_hl21
  s_branch KM_hr21
KM_hs22:
  s_add_u32 s40, s41, 45056
  s_mov_b32 s46, 0x8000
KM_hl22:
  s_mov_b64 exec, vcc
  s_sleep 2
  buffer_load_dwordx4 v[84:87], v6, s[12:15], s40 offen sc1
  s_waitcnt vmcnt(0)
  v_max3_u32 v9, v84, v85, v86
  v_max_u32 v9, v9, v87
  v_cmp_eq_u32 vcc, -1, v9
  s_mov_b64 exec, -1
  s_sub_u32 s46, s46, 1
  s_cmp_eq_u32 s46, 0
  s_cbranch_scc1 KM_hr22
  s_cmp_lg_u64 vcc, 0
  s_cbranch_scc1 KM_hl22
  s_branch KM_hr22
KM_hs23:
  s_add_u32 s40, s41, 47104
  s_mov_b32 s46, 0x8000
KM_hl23:
  s_mov_b64 exec, vcc
  s_sleep 2
  buffer_load_dwordx4 v[88:91], v6, s[12:15], s40 offen sc1
  s_waitcnt vmcnt(0)
  v_max3_u32 v9, v88, v89, v90
  v_max_u32 v9, v9, v91
  v_cmp_eq_u32 vcc, -1, v9
  s_mov_b64 exec, -1
  s_sub_u32 s46, s46, 1
  s_cmp_eq_u32 s46, 0
  s_cbranch_scc1 KM_hr23
  s_cmp_lg_u64 vcc, 0
  s_cbranch_scc1 KM_hl23
  s_branch KM_hr23
KM_prod:
  s_sub_u32 s47, s22, 8
  s_waitcnt lgkmcnt(0)
  s_mov_b32 s12, s6
  s_mov_b32 s13, s7
  s_mov_b32 s14, 31457280
  s_mov_b32 s15, 0x00020000
  s_mov_b32 s16, s60
  s_mov_b32 s17, s61
  s_mov_b32 s18, 256
  s_mov_b32 s19, 0x00020000
  v_mov_b32 v60, 0
  s_load_dwordx4 s[56:59], s[0:1], 32
  s_load_dwordx2 s[4:5], s[0:1], 48
  v_lshlrev_b32 v59, 4, v1
  s_sub_u32 s53, s2, 80
  s_xor_b32 s54, s47, 2
  s_mul_i32 s54, s54, 192
  s_sub_u32 s21, s2, 64
  s_add_u32 s54, s54, s21
  s_cmp_lt_u32 s2, 64
  s_cselect_b32 s54, 999, s54
  s_cmp_ge_u32 s47, 2
  s_cbranch_scc1 KM_p_wp
  s_cmp_lg_u32 s47, 0
  s_cbranch_scc1 KM_p_pf
  s_branch KM_p_no0
KM_p_pf:
  s_cmp_lt_u32 s2, 240
  s_cbranch_scc1 KM_p_no0
  s_getpc_b64 s[38:39]
KM_pc:
  s_sub_u32 s38, s38, KM_pc-adaLN_cond__spectral_gfnet__glu_gated_geglu__prompt_kernel
  s_subb_u32 s39, s39, 0
  v_lshlrev_b32 v86, 7, v1
  v_add_u32 v87, 0, v86
  v_min_u32 v87, KM_end-adaLN_cond__spectral_gfnet__glu_gated_geglu__prompt_kernel, v87
  global_load_dword v88, v87, s[38:39]
  v_add_u32 v87, 8192, v86
  v_min_u32 v87, KM_end-adaLN_cond__spectral_gfnet__glu_gated_geglu__prompt_kernel, v87
  global_load_dword v89, v87, s[38:39]
  v_add_u32 v87, 16384, v86
  v_min_u32 v87, KM_end-adaLN_cond__spectral_gfnet__glu_gated_geglu__prompt_kernel, v87
  global_load_dword v90, v87, s[38:39]
  v_add_u32 v87, 24576, v86
  v_min_u32 v87, KM_end-adaLN_cond__spectral_gfnet__glu_gated_geglu__prompt_kernel, v87
  global_load_dword v91, v87, s[38:39]
KM_p_no0:
  s_waitcnt lgkmcnt(0)
  s_barrier
  v_mov_b32 v62, 99840
  ds_read_b32 v61, v62
  s_mul_i32 s23, s47, 5120
  s_add_u32 s23, s23, 16384
  s_add_u32 s21, s23, 4096
  v_lshlrev_b32 v62, 4, v1
  s_mul_i32 s24, s47, 2560
  s_add_u32 s24, s24, 100352
  v_lshlrev_b32 v63, 3, v1
  v_add_u32 v63, s24, v63
  s_lshl_b32 s25, s2, 7
  s_add_u32 s25, s25, 131072
  s_lshl_b32 s26, s47, 14
  s_add_u32 s26, s26, 131072
  s_add_u32 s27, s26, 8192
  v_lshlrev_b32 v58, 7, v1
  s_waitcnt lgkmcnt(0)
  s_cmp_lg_u32 s47, 0
  s_cbranch_scc1 KM_p_nf
  s_mov_b64 exec, 1
  buffer_store_dword v61, v60, s[12:15], s25 offen sc1
  s_mov_b64 exec, -1
KM_p_nf:
  s_mov_b32 s46, 0x8000
KM_pg:
  buffer_load_dwordx4 v[8:11], v62, s[12:15], s23 offen offset:0 sc1
  buffer_load_dwordx4 v[12:15], v62, s[12:15], s23 offen offset:1024 sc1
  buffer_load_dwordx4 v[16:19], v62, s[12:15], s23 offen offset:2048 sc1
  buffer_load_dwordx4 v[20:23], v62, s[12:15], s23 offen offset:3072 sc1
  buffer_load_dwordx4 v[24:27], v62, s[12:15], s21 offen offset:0 sc1
  s_waitcnt vmcnt(0)
  v_cmp_ne_u32 vcc, v9, v61
  v_cmp_ne_u32 s[38:39], v11, v61
  s_nop 0
  s_or_b64 vcc, vcc, s[38:39]
  v_cmp_ne_u32 s[38:39], v13, v61
  s_nop 0
  s_or_b64 vcc, vcc, s[38:39]
  v_cmp_ne_u32 s[38:39], v15, v61
  s_nop 0
  s_or_b64 vcc, vcc, s[38:39]
  v_cmp_ne_u32 s[38:39], v17, v61
  s_nop 0
  s_or_b64 vcc, vcc, s[38:39]
  v_cmp_ne_u32 s[38:39], v19, v61
  s_nop 0
  s_or_b64 vcc, vcc, s[38:39]
  v_cmp_ne_u32 s[38:39], v21, v61
  s_nop 0
  s_or_b64 vcc, vcc, s[38:39]
  v_cmp_ne_u32 s[38:39], v23, v61
  s_nop 0
  s_or_b64 vcc, vcc, s[38:39]
  v_cmp_ne_u32 s[38:39], v25, v61
  s_nop 0
  s_or_b64 vcc, vcc, s[38:39]
  v_cmp_ne_u32 s[38:39], v27, v61
  s_nop 0
  s_or_b64 vcc, vcc, s[38:39]
  s_nop 1
  s_and_b64 exec, exec, vcc
  s_cbranch_scc0 KM_pg_ok
  s_sleep 4
  s_sub_u32 s46, s46, 1
  s_cmp_lg_u32 s46, 0
  s_cbranch_scc1 KM_pg
KM_pg_ok:
  s_mov_b64 exec, -1
  v_mov_b32 v9, v10
  ds_write_b64 v63, v[8:9] offset:0
  v_mov_b32 v13, v14
  ds_write_b64 v63, v[12:13] offset:512
  v_mov_b32 v17, v18
  ds_write_b64 v63, v[16:17] offset:1024
  v_mov_b32 v21, v22
  ds_write_b64 v63, v[20:21] offset:1536
  v_mov_b32 v25, v26
  ds_write_b64 v63, v[24:25] offset:2048
  s_waitcnt lgkmcnt(0)
  s_barrier
  s_mov_b32 s46, 0x8000
KM_A_p:
  buffer_load_dword v11, v58, s[12:15], s26 offen sc1
  buffer_load_dword v12, v58, s[12:15], s27 offen sc1
  s_waitcnt vmcnt(0)
  v_cmp_ne_u32 vcc, v11, v61
  v_cmp_ne_u32 s[38:39], v12, v61
  s_nop 0
  s_or_b64 vcc, vcc, s[38:39]
  s_nop 1
  s_and_b64 exec, exec, vcc
  s_cbranch_scc0 KM_A_p_ok
  s_sleep 4
  s_sub_u32 s46, s46, 1
  s_cmp_lg_u32 s46, 0
  s_cbranch_scc1 KM_A_p
KM_A_p_ok:
  s_mov_b64 exec, -1
  s_branch KM_p_ag2
KM_p_wp:
  s_sub_u32 s21, s47, 2
  s_sub_u32 s40, s47, 2
  s_lshl_b32 s28, s40, 2
  s_lshr_b32 s29, s2, 6
  s_add_u32 s28, s28, s29
  s_lshl_b32 s28, s28, 3
  s_and_b32 s29, s2, 7
  s_add_u32 s28, s28, s29
  s_lshl_b32 s41, s28, 16
  s_lshl_b32 s28, s28, 3
  s_bfe_u32 s29, s2, 0x30003
  s_add_u32 s28, s28, s29
  s_lshl_b32 s29, s29, 4
  s_add_u32 s41, s41, s29
  s_cmp_gt_u32 s28, 320
  s_cbranch_scc1 KM_p_nyf
  s_lshl_b32 s28, s28, 13
  s_add_u32 s28, s28, 4194304
  s_add_u32 s29, s28, 4096
  v_mov_b32 v64, -1
  v_mov_b32 v65, -1
  v_mov_b32 v66, -1
  v_mov_b32 v67, -1
  buffer_store_dwordx4 v[64:67], v59, s[12:15], s28 offen offset:0 sc1
  buffer_store_dwordx4 v[64:67], v59, s[12:15], s28 offen offset:1024 sc1
  buffer_store_dwordx4 v[64:67], v59, s[12:15], s28 offen offset:2048 sc1
  buffer_store_dwordx4 v[64:67], v59, s[12:15], s28 offen offset:3072 sc1
  buffer_store_dwordx4 v[64:67], v59, s[12:15], s29 offen offset:0 sc1
  buffer_store_dwordx4 v[64:67], v59, s[12:15], s29 offen offset:1024 sc1
  buffer_store_dwordx4 v[64:67], v59, s[12:15], s29 offen offset:2048 sc1
  buffer_store_dwordx4 v[64:67], v59, s[12:15], s29 offen offset:3072 sc1
KM_p_nyf:
  s_mul_i32 s21, s21, 176
  s_add_u32 s21, s21, s53
  s_cmp_lt_u32 s2, 80
  s_cbranch_scc1 KM_p_nowp
  s_lshl_b32 s45, s47, 13
  s_movk_i32 s46, 640
  s_and_b32 s28, s21, 31
  s_lshr_b32 s29, s21, 5
  s_and_b32 s30, s28, 3
  s_lshl_b32 s31, s30, 4
  s_lshl_b32 s30, s30, 11
  s_bfe_u32 s23, s28, 0x10002
  s_lshl_b32 s23, s23, 10
  s_add_u32 s31, s31, s23
  s_add_u32 s30, s30, s23
  s_lshr_b32 s23, s28, 3
  s_lshl_b32 s23, s23, 8
  s_add_u32 s31, s31, s23
  s_add_u32 s30, s30, s23
  s_mul_i32 s31, s31, 642
  s_lshl_b32 s28, s29, 5
  s_min_u32 s28, s28, 314
  s_lshl_b32 s23, s28, 1
  s_add_u32 s31, s31, s23
  s_lshl_b32 s23, s28, 13
  s_add_u32 s30, s30, s23
  s_add_u32 s30, s30, 7340032
  v_and_b32 v1, 15, v0
  v_bfe_u32 v2, v0, 4, 2
  v_bfe_u32 v3, v0, 2, 3
  v_bfe_u32 v5, v0, 5, 1
  v_mul_u32_u24 v3, 1284, v3
  v_mad_u32_u24 v3, v5, s46, v3
  v_and_b32 v6, 3, v0
  v_lshl_add_u32 v3, v6, 4, v3
  v_bfe_u32 v7, v0, 2, 4
  v_lshl_add_u32 v6, v6, 4, v7
  v_lshlrev_b32 v6, 4, v6
  v_add_u32 v6, s45, v6
  v_and_b32 v7, 63, v0
  v_lshlrev_b32 v7, 4, v7
  v_add_u32 v7, s45, v7
  v_bfe_u32 v5, v0, 3, 1
  v_lshlrev_b32 v4, 4, v1
  v_lshl_add_u32 v4, v2, 16, v4
  v_xor_b32 v5, 1, v5
  v_lshl_add_u32 v4, v5, 13, v4
  s_sub_u32 s30, s30, 8192
  s_mov_b32 s8, s24
  s_mov_b32 s9, s25
  s_mov_b32 s10, 1314816
  s_mov_b32 s11, 0x00020000
  s_mov_b32 s24, s26
  s_mov_b32 s25, s27
  s_mov_b32 s26, 1314816
  s_mov_b32 s27, 0x00020000
  s_cmp_eq_u32 s29, 10
  s_cselect_b32 exec_lo, 0x11111111, -1
  s_cselect_b32 exec_hi, 0x11111111, -1
  buffer_load_dwordx4 v[8:11], v3, s[8:11], s31 offen
  buffer_load_dwordx4 v[24:27], v3, s[24:27], s31 offen
  s_add_u32 s31, s31, 41088
  buffer_load_dwordx4 v[12:15], v3, s[8:11], s31 offen
  buffer_load_dwordx4 v[28:31], v3, s[24:27], s31 offen
  s_add_u32 s31, s31, 41088
  buffer_load_dwordx4 v[16:19], v3, s[8:11], s31 offen
  buffer_load_dwordx4 v[32:35], v3, s[24:27], s31 offen
  s_add_u32 s31, s31, 41088
  buffer_load_dwordx4 v[20:23], v3, s[8:11], s31 offen
  buffer_load_dwordx4 v[36:39], v3, s[24:27], s31 offen
  s_mov_b32 s28, 0x05040100
  s_mov_b32 s23, 0x07060302
  s_barrier
  s_waitcnt vmcnt(0)
  v_perm_b32 v40, v24, v8, s28
  v_perm_b32 v41, v28, v12, s28
  v_perm_b32 v42, v32, v16, s28
  v_perm_b32 v43, v36, v20, s28
  ds_write_b128 v6, v[40:43] offset:0
  v_perm_b32 v44, v24, v8, s23
  v_perm_b32 v45, v28, v12, s23
  v_perm_b32 v46, v32, v16, s23
  v_perm_b32 v47, v36, v20, s23
  ds_write_b128 v6, v[44:47] offset:1024
  v_perm_b32 v40, v25, v9, s28
  v_perm_b32 v41, v29, v13, s28
  v_perm_b32 v42, v33, v17, s28
  v_perm_b32 v43, v37, v21, s28
  ds_write_b128 v6, v[40:43] offset:2048
  v_perm_b32 v44, v25, v9, s23
  v_perm_b32 v45, v29, v13, s23
  v_perm_b32 v46, v33, v17, s23
  v_perm_b32 v47, v37, v21, s23
  ds_write_b128 v6, v[44:47] offset:3072
  v_perm_b32 v40, v26, v10, s28
  v_perm_b32 v41, v30, v14, s28
  v_perm_b32 v42, v34, v18, s28
  v_perm_b32 v43, v38, v22, s28
  ds_write_b128 v6, v[40:43] offset:4096
  v_perm_b32 v44, v26, v10, s23
  v_perm_b32 v45, v30, v14, s23
  v_perm_b32 v46, v34, v18, s23
  v_perm_b32 v47, v38, v22, s23
  ds_write_b128 v6, v[44:47] offset:5120
  v_perm_b32 v40, v27, v11, s28
  v_perm_b32 v41, v31, v15, s28
  v_perm_b32 v42, v35, v19, s28
  v_perm_b32 v43, v39, v23, s28
  ds_write_b128 v6, v[40:43] offset:6144
  v_perm_b32 v44, v27, v11, s23
  v_perm_b32 v45, v31, v15, s23
  v_perm_b32 v46, v35, v19, s23
  v_perm_b32 v47, v39, v23, s23
  ds_write_b128 v6, v[44:47] offset:7168
  s_cmp_eq_u32 s29, 10
  s_cselect_b64 exec, 0xffff, -1
  s_waitcnt lgkmcnt(0)
  ds_read_b128 v[8:11], v7 offset:0
  ds_read_b128 v[12:15], v7 offset:1024
  ds_read_b128 v[16:19], v7 offset:2048
  ds_read_b128 v[20:23], v7 offset:3072
  ds_read_b128 v[24:27], v7 offset:4096
  ds_read_b128 v[28:31], v7 offset:5120
  ds_read_b128 v[32:35], v7 offset:6144
  ds_read_b128 v[36:39], v7 offset:7168
  s_waitcnt lgkmcnt(7)
  buffer_store_dwordx4 v[8:11], v4, s[12:15], s30 offen sc1
  s_add_u32 s30, s30, 8192
  s_waitcnt lgkmcnt(6)
  buffer_store_dwordx4 v[12:15], v4, s[12:15], s30 offen sc1
  s_add_u32 s30, s30, 8192
  s_waitcnt lgkmcnt(5)
  buffer_store_dwordx4 v[16:19], v4, s[12:15], s30 offen sc1
  s_add_u32 s30, s30, 8192
  s_waitcnt lgkmcnt(4)
  buffer_store_dwordx4 v[20:23], v4, s[12:15], s30 offen sc1
  s_add_u32 s30, s30, 8192
  s_waitcnt lgkmcnt(3)
  buffer_store_dwordx4 v[24:27], v4, s[12:15], s30 offen sc1
  s_add_u32 s30, s30, 8192
  s_waitcnt lgkmcnt(2)
  buffer_store_dwordx4 v[28:31], v4, s[12:15], s30 offen sc1
  s_add_u32 s30, s30, 8192
  s_waitcnt lgkmcnt(1)
  buffer_store_dwordx4 v[32:35], v4, s[12:15], s30 offen sc1
  s_add_u32 s30, s30, 8192
  s_waitcnt lgkmcnt(0)
  buffer_store_dwordx4 v[36:39], v4, s[12:15], s30 offen sc1
  s_mov_b64 exec, -1
  s_branch KM_p_wd
KM_p_nowp:
  s_barrier
KM_p_wd:
  v_and_b32 v2, 63, v0
  s_waitcnt lgkmcnt(0)
  s_barrier
KM_p_ag2:
  v_mov_b32 v62, 99840
  ds_read_b32 v61, v62
  v_and_b32 v2, 63, v0
  s_waitcnt vmcnt(0) lgkmcnt(0)
  s_cmp_lt_u32 s47, 2
  s_cselect_b32 s8, s56, s58
  s_cselect_b32 s9, s57, s59
  s_mov_b32 s10, 1966080
  s_mov_b32 s11, 0x00020000
  s_barrier
  s_or_b32 s23, s2, s47
  s_cmp_lg_u32 s23, 0
  s_cbranch_scc1 KM_p_nr
  s_mov_b64 exec, 1
  buffer_store_dword v60, v60, s[16:19], 0 offen sc1
  s_mov_b64 exec, -1
KM_p_nr:
  s_mov_b32 s16, s4
  s_mov_b32 s17, s5
  s_mov_b32 s18, 1966080
  s_mov_b32 s19, 0x00020000
  s_cmp_ge_u32 s54, 384
  s_cbranch_scc1 KM_p_nwd
  s_lshr_b32 s24, s54, 3
  s_and_b32 s25, s54, 7
  s_mul_i32 s55, s25, 245760
  s_mul_i32 s21, s24, 5120
  s_add_u32 s55, s55, s21
  s_add_u32 s55, s55, 29360128
  s_mul_i32 s24, s24, 40960
  s_mul_i32 s25, s25, 160
  s_add_u32 s24, s24, s25
  v_add_u32 v12, 0, v2
  v_mul_u32_u24 v14, 52429, v12
  v_lshrrev_b32 v14, 19, v14
  v_mul_u32_u24 v15, 10, v14
  v_sub_u32 v15, v12, v15
  v_and_b32 v36, 3, v14
  v_bfe_u32 v37, v14, 2, 2
  v_lshl_add_u32 v36, v37, 3, v36
  v_lshrrev_b32 v37, 4, v14
  v_lshl_add_u32 v36, v37, 2, v36
  v_mul_u32_u24 v36, 1280, v36
  v_lshl_add_u32 v36, v15, 4, v36
  buffer_load_dwordx4 v[64:67], v36, s[16:19], s24 offen
  v_add_u32 v12, 64, v2
  v_mul_u32_u24 v14, 52429, v12
  v_lshrrev_b32 v14, 19, v14
  v_mul_u32_u24 v15, 10, v14
  v_sub_u32 v15, v12, v15
  v_and_b32 v36, 3, v14
  v_bfe_u32 v37, v14, 2, 2
  v_lshl_add_u32 v36, v37, 3, v36
  v_lshrrev_b32 v37, 4, v14
  v_lshl_add_u32 v36, v37, 2, v36
  v_mul_u32_u24 v36, 1280, v36
  v_lshl_add_u32 v36, v15, 4, v36
  buffer_load_dwordx4 v[68:71], v36, s[16:19], s24 offen
  v_add_u32 v12, 128, v2
  v_mul_u32_u24 v14, 52429, v12
  v_lshrrev_b32 v14, 19, v14
  v_mul_u32_u24 v15, 10, v14
  v_sub_u32 v15, v12, v15
  v_and_b32 v36, 3, v14
  v_bfe_u32 v37, v14, 2, 2
  v_lshl_add_u32 v36, v37, 3, v36
  v_lshrrev_b32 v37, 4, v14
  v_lshl_add_u32 v36, v37, 2, v36
  v_mul_u32_u24 v36, 1280, v36
  v_lshl_add_u32 v36, v15, 4, v36
  buffer_load_dwordx4 v[72:75], v36, s[16:19], s24 offen
  v_add_u32 v12, 192, v2
  v_mul_u32_u24 v14, 52429, v12
  v_lshrrev_b32 v14, 19, v14
  v_mul_u32_u24 v15, 10, v14
  v_sub_u32 v15, v12, v15
  v_and_b32 v36, 3, v14
  v_bfe_u32 v37, v14, 2, 2
  v_lshl_add_u32 v36, v37, 3, v36
  v_lshrrev_b32 v37, 4, v14
  v_lshl_add_u32 v36, v37, 2, v36
  v_mul_u32_u24 v36, 1280, v36
  v_lshl_add_u32 v36, v15, 4, v36
  buffer_load_dwordx4 v[76:79], v36, s[16:19], s24 offen
  v_add_u32 v12, 256, v2
  v_mul_u32_u24 v14, 52429, v12
  v_lshrrev_b32 v14, 19, v14
  v_mul_u32_u24 v15, 10, v14
  v_sub_u32 v15, v12, v15
  v_and_b32 v36, 3, v14
  v_bfe_u32 v37, v14, 2, 2
  v_lshl_add_u32 v36, v37, 3, v36
  v_lshrrev_b32 v37, 4, v14
  v_lshl_add_u32 v36, v37, 2, v36
  v_mul_u32_u24 v36, 1280, v36
  v_lshl_add_u32 v36, v15, 4, v36
  buffer_load_dwordx4 v[80:83], v36, s[16:19], s24 offen
KM_p_nwd:
  s_cmp_lt_u32 s47, 2
  s_cbranch_scc1 KM_p_nt
  s_mov_b64 s[44:45], exec
  s_mov_b64 exec, -1
  s_waitcnt lgkmcnt(0)
  s_cmp_eq_u32 s47, 2
  s_cselect_b32 s16, s56, s58
  s_cselect_b32 s17, s57, s59
  s_mov_b32 s18, 1966080
  s_mov_b32 s19, 0x00020000
  s_mul_i32 s40, s2, 7680
  v_and_b32 v84, 63, v0
  v_min_u32 v84, 59, v84
  v_lshlrev_b32 v84, 7, v84
  buffer_load_dword v85, v84, s[16:19], s40 offen
  s_mov_b64 exec, s[44:45]
KM_p_nt:
  v_add_u32 v10, 0, v2
  v_mul_u32_u24 v11, 43691, v10
  v_lshrrev_b32 v11, 19, v11
  v_mul_u32_u24 v12, 12, v11
  v_sub_u32 v12, v10, v12
  v_lshrrev_b32 v13, 2, v11
  v_and_b32 v13, 2, v13
  v_xor_b32 v12, v12, v13
  v_mul_u32_u24 v11, 3072, v11
  v_lshl_add_u32 v11, v12, 4, v11
  v_subrev_u32 v50, 0, v11
  v_add_u32 v10, 64, v2
  v_mul_u32_u24 v11, 43691, v10
  v_lshrrev_b32 v11, 19, v11
  v_mul_u32_u24 v12, 12, v11
  v_sub_u32 v12, v10, v12
  v_lshrrev_b32 v13, 2, v11
  v_and_b32 v13, 2, v13
  v_xor_b32 v12, v12, v13
  v_mul_u32_u24 v11, 3072, v11
  v_lshl_add_u32 v11, v12, 4, v11
  v_subrev_u32 v51, 1024, v11
  v_add_u32 v10, 128, v2
  v_mul_u32_u24 v11, 43691, v10
  v_lshrrev_b32 v11, 19, v11
  v_mul_u32_u24 v12, 12, v11
  v_sub_u32 v12, v10, v12
  v_lshrrev_b32 v13, 2, v11
  v_and_b32 v13, 2, v13
  v_xor_b32 v12, v12, v13
  v_mul_u32_u24 v11, 3072, v11
  v_lshl_add_u32 v11, v12, 4, v11
  v_subrev_u32 v52, 2048, v11
  v_lshrrev_b32 v10, 4, v2
  v_add_u32 v10, 0, v10
  v_xor_b32 v10, v10, v2
  v_and_b32 v10, 7, v10
  v_lshrrev_b32 v11, 3, v2
  v_mul_u32_u24 v11, 1280, v11
  v_lshl_add_u32 v11, v10, 4, v11
  v_add_u32 v53, 0, v11
  v_lshrrev_b32 v10, 4, v2
  v_add_u32 v10, 4, v10
  v_xor_b32 v10, v10, v2
  v_and_b32 v10, 7, v10
  v_lshrrev_b32 v11, 3, v2
  v_mul_u32_u24 v11, 1280, v11
  v_lshl_add_u32 v11, v10, 4, v11
  v_add_u32 v54, 9216, v11
  v_lshrrev_b32 v10, 4, v2
  v_add_u32 v10, 8, v10
  v_xor_b32 v10, v10, v2
  v_and_b32 v10, 7, v10
  v_lshrrev_b32 v11, 3, v2
  v_mul_u32_u24 v11, 1280, v11
  v_lshl_add_u32 v11, v10, 4, v11
  v_add_u32 v55, 18432, v11
  v_lshrrev_b32 v10, 4, v2
  v_add_u32 v10, 12, v10
  v_xor_b32 v10, v10, v2
  v_and_b32 v10, 7, v10
  v_lshrrev_b32 v11, 3, v2
  v_mul_u32_u24 v11, 1280, v11
  v_lshl_add_u32 v11, v10, 4, v11
  v_add_u32 v56, 27648, v11
  s_and_b32 s26, s47, 1
  s_mul_i32 s27, s26, 49152
  s_mul_i32 s28, s51, 192
  s_add_u32 s27, s27, s28
  s_mul_i32 s28, s47, 3072
  s_lshl_b32 s29, s50, 2
  s_add_u32 s29, s29, s47
  s_mul_i32 s29, s29, 40960
  s_add_u32 s29, s29, 13631488
  s_lshl_b32 s30, s47, 12
  v_and_b32 v58, 15, v2
  v_lshlrev_b32 v58, 7, v58
  v_and_b32 v57, 3, v2
  v_lshlrev_b32 v57, 7, v57
  v_lshlrev_b32 v59, 4, v2
  v_lshlrev_b32 v63, 7, v2
  s_barrier
  s_cmp_ge_u32 s54, 384
  s_cbranch_scc1 KM_p_nwd2
  s_add_u32 s54, s55, 4096
  s_waitcnt vmcnt(0)
  buffer_store_dwordx4 v[64:67], v59, s[12:15], s55 offen offset:0 sc1
  buffer_store_dwordx4 v[68:71], v59, s[12:15], s55 offen offset:1024 sc1
  buffer_store_dwordx4 v[72:75], v59, s[12:15], s55 offen offset:2048 sc1
  buffer_store_dwordx4 v[76:79], v59, s[12:15], s55 offen offset:3072 sc1
  buffer_store_dwordx4 v[80:83], v59, s[12:15], s54 offen offset:0 sc1
KM_p_nwd2:
  s_lshl_b32 s23, s47, 11
  s_add_u32 m0, s23, 155648
  s_add_u32 s23, s23, 5120
  buffer_load_dwordx4 v59, s[12:15], s23 offen sc1 lds
  buffer_load_dwordx4 v59, s[12:15], s23 offen offset:1024 sc1 lds
  s_add_u32 m0, s28, 0
  s_nop 0
  buffer_load_dwordx4 v50, s[8:11], s27 offen offset:0 sc1 lds
  buffer_load_dwordx4 v51, s[8:11], s27 offen offset:1024 sc1 lds
  buffer_load_dwordx4 v52, s[8:11], s27 offen offset:2048 sc1 lds
  s_add_u32 s27, s27, 98304
  s_add_u32 m0, s28, 12288
  s_nop 0
  buffer_load_dwordx4 v50, s[8:11], s27 offen offset:0 sc1 lds
  buffer_load_dwordx4 v51, s[8:11], s27 offen offset:1024 sc1 lds
  buffer_load_dwordx4 v52, s[8:11], s27 offen offset:2048 sc1 lds
  s_add_u32 s27, s27, 98304
  s_add_u32 m0, s28, 24576
  s_nop 0
  buffer_load_dwordx4 v50, s[8:11], s27 offen offset:0 sc1 lds
  buffer_load_dwordx4 v51, s[8:11], s27 offen offset:1024 sc1 lds
  buffer_load_dwordx4 v52, s[8:11], s27 offen offset:2048 sc1 lds
  s_add_u32 s27, s27, 98304
  s_add_u32 m0, s28, 36864
  s_nop 0
  buffer_load_dwordx4 v50, s[8:11], s27 offen offset:0 sc1 lds
  buffer_load_dwordx4 v51, s[8:11], s27 offen offset:1024 sc1 lds
  buffer_load_dwordx4 v52, s[8:11], s27 offen offset:2048 sc1 lds
  s_add_u32 s27, s27, 98304
  s_waitcnt vmcnt(12)
  s_barrier
  s_lshl_b32 s23, s50, 3
  s_lshl_b32 s24, s47, 1
  s_add_u32 s23, s23, s24
  s_mul_i32 s23, s23, 49152
  s_mul_i32 s24, s51, 3072
  s_add_u32 s23, s23, s24
  s_add_u32 s23, s23, 16777216
  s_add_u32 s24, s23, 49152
  v_mov_b32 v88, -1
  v_mov_b32 v89, -1
  v_mov_b32 v90, -1
  v_mov_b32 v91, -1
  s_barrier
  buffer_store_dwordx4 v[88:91], v59, s[12:15], s23 offen offset:0 sc1
  buffer_store_dwordx4 v[88:91], v59, s[12:15], s23 offen offset:1024 sc1
  buffer_store_dwordx4 v[88:91], v59, s[12:15], s23 offen offset:2048 sc1
  buffer_store_dwordx4 v[88:91], v59, s[12:15], s24 offen offset:0 sc1
  buffer_store_dwordx4 v[88:91], v59, s[12:15], s24 offen offset:1024 sc1
  buffer_store_dwordx4 v[88:91], v59, s[12:15], s24 offen offset:2048 sc1
  s_barrier
  s_barrier
  s_lshl_b32 s48, s50, 4
  s_add_u32 s48, s48, s51
  s_lshl_b32 s48, s48, 7
  s_add_u32 s48, s48, 65536
  s_lshl_b32 s23, s50, 2
  s_add_u32 s23, s23, s47
  s_lshl_b32 s23, s23, 9
  s_add_u32 s23, s23, 65536
  s_and_b32 s24, s51, 7
  s_mul_i32 s31, s47, 2560
  s_mul_i32 s32, s24, 245760
  s_add_u32 s32, s32, s31
  s_add_u32 s32, s32, 29360128
  s_waitcnt vmcnt(0)
  s_barrier
  s_cmp_lg_u32 s47, 0
  s_cbranch_scc1 KM_na1
  s_mov_b64 exec, 1
  buffer_store_dword v61, v60, s[12:15], s48 offen sc1
  s_mov_b64 exec, -1
KM_na1:
  v_add_u32 v62, s30, v59
  v_add_u32 v62, 98304, v62
  buffer_load_dwordx4 v[96:99], v53, s[12:15], s29 offen offset:0 sc1
  buffer_load_dwordx4 v[100:103], v54, s[12:15], s29 offen offset:1024 sc1
  buffer_load_dwordx4 v[104:107], v55, s[12:15], s29 offen offset:2048 sc1
  buffer_load_dwordx4 v[108:111], v56, s[12:15], s29 offen offset:3072 sc1
  buffer_load_dwordx4 v[112:115], v53, s[12:15], s29 offen offset:128 sc1
  buffer_load_dwordx4 v[116:119], v54, s[12:15], s29 offen offset:1152 sc1
  buffer_load_dwordx4 v[120:123], v55, s[12:15], s29 offen offset:2176 sc1
  buffer_load_dwordx4 v[124:127], v56, s[12:15], s29 offen offset:3200 sc1
  buffer_load_dwordx4 v[128:131], v53, s[12:15], s29 offen offset:256 sc1
  buffer_load_dwordx4 v[132:135], v54, s[12:15], s29 offen offset:1280 sc1
  buffer_load_dwordx4 v[136:139], v55, s[12:15], s29 offen offset:2304 sc1
  buffer_load_dwordx4 v[140:143], v56, s[12:15], s29 offen offset:3328 sc1
  buffer_load_dwordx4 v[144:147], v53, s[12:15], s29 offen offset:384 sc1
  buffer_load_dwordx4 v[148:151], v54, s[12:15], s29 offen offset:1408 sc1
  buffer_load_dwordx4 v[152:155], v55, s[12:15], s29 offen offset:2432 sc1
  buffer_load_dwordx4 v[156:159], v56, s[12:15], s29 offen offset:3456 sc1
  s_add_u32 m0, s28, 49152
  s_nop 0
  buffer_load_dwordx4 v50, s[8:11], s27 offen offset:0 sc1 lds
  buffer_load_dwordx4 v51, s[8:11], s27 offen offset:1024 sc1 lds
  buffer_load_dwordx4 v52, s[8:11], s27 offen offset:2048 sc1 lds
  s_add_u32 s27, s27, 98304
  s_add_u32 m0, s28, 61440
  s_nop 0
  buffer_load_dwordx4 v50, s[8:11], s27 offen offset:0 sc1 lds
  buffer_load_dwordx4 v51, s[8:11], s27 offen offset:1024 sc1 lds
  buffer_load_dwordx4 v52, s[8:11], s27 offen offset:2048 sc1 lds
  s_add_u32 s27, s27, 98304
  s_add_u32 m0, s28, 73728
  s_nop 0
  buffer_load_dwordx4 v50, s[8:11], s27 offen offset:0 sc1 lds
  buffer_load_dwordx4 v51, s[8:11], s27 offen offset:1024 sc1 lds
  buffer_load_dwordx4 v52, s[8:11], s27 offen offset:2048 sc1 lds
  s_add_u32 s27, s27, 98304
  s_add_u32 m0, s28, 86016
  s_nop 0
  buffer_load_dwordx4 v50, s[8:11], s27 offen offset:0 sc1 lds
  buffer_load_dwordx4 v51, s[8:11], s27 offen offset:1024 sc1 lds
  buffer_load_dwordx4 v52, s[8:11], s27 offen offset:2048 sc1 lds
  s_add_u32 s27, s27, 98304
  s_mov_b32 s46, 0x8000
  s_waitcnt vmcnt(24)
  s_branch KM_hc0
KM_hq0:
  s_sleep 2
  buffer_load_dwordx4 v[96:99], v53, s[12:15], s29 offen offset:0 sc1
  buffer_load_dwordx4 v[100:103], v54, s[12:15], s29 offen offset:1024 sc1
  buffer_load_dwordx4 v[104:107], v55, s[12:15], s29 offen offset:2048 sc1
  buffer_load_dwordx4 v[108:111], v56, s[12:15], s29 offen offset:3072 sc1
  s_waitcnt vmcnt(0)
KM_hc0:
  v_max3_u32 v12, v96, v97, v98
  v_max3_u32 v12, v12, v99, v100
  v_max3_u32 v12, v12, v101, v102
  v_max3_u32 v12, v12, v103, v104
  v_max3_u32 v12, v12, v105, v106
  v_max3_u32 v12, v12, v107, v108
  v_max3_u32 v12, v12, v109, v110
  v_max_u32 v12, v12, v111
  v_cmp_eq_u32 vcc, -1, v12
  s_nop 1
  s_and_b64 exec, exec, vcc
  s_cbranch_scc0 KM_ho0
  s_sub_u32 s46, s46, 1
  s_cmp_lg_u32 s46, 0
  s_cbranch_scc1 KM_hq0
KM_ho0:
  s_mov_b64 exec, -1
  ds_write_b128 v62, v[96:99] offset:0
  ds_write_b128 v62, v[100:103] offset:1024
  ds_write_b128 v62, v[104:107] offset:2048
  ds_write_b128 v62, v[108:111] offset:3072
  s_waitcnt lgkmcnt(0)
  s_barrier
  s_mov_b32 s46, 0x8000
  s_waitcnt vmcnt(20)
  s_branch KM_hc1
KM_hq1:
  s_sleep 2
  buffer_load_dwordx4 v[112:115], v53, s[12:15], s29 offen offset:128 sc1
  buffer_load_dwordx4 v[116:119], v54, s[12:15], s29 offen offset:1152 sc1
  buffer_load_dwordx4 v[120:123], v55, s[12:15], s29 offen offset:2176 sc1
  buffer_load_dwordx4 v[124:127], v56, s[12:15], s29 offen offset:3200 sc1
  s_waitcnt vmcnt(0)
KM_hc1:
  v_max3_u32 v12, v112, v113, v114
  v_max3_u32 v12, v12, v115, v116
  v_max3_u32 v12, v12, v117, v118
  v_max3_u32 v12, v12, v119, v120
  v_max3_u32 v12, v12, v121, v122
  v_max3_u32 v12, v12, v123, v124
  v_max3_u32 v12, v12, v125, v126
  v_max_u32 v12, v12, v127
  v_cmp_eq_u32 vcc, -1, v12
  s_nop 1
  s_and_b64 exec, exec, vcc
  s_cbranch_scc0 KM_ho1
  s_sub_u32 s46, s46, 1
  s_cmp_lg_u32 s46, 0
  s_cbranch_scc1 KM_hq1
KM_ho1:
  s_mov_b64 exec, -1
  ds_write_b128 v62, v[112:115] offset:16384
  ds_write_b128 v62, v[116:119] offset:17408
  ds_write_b128 v62, v[120:123] offset:18432
  ds_write_b128 v62, v[124:127] offset:19456
  s_waitcnt lgkmcnt(0)
  s_barrier
  s_add_u32 m0, s28, 0
  s_nop 0
  buffer_load_dwordx4 v50, s[8:11], s27 offen offset:0 sc1 lds
  buffer_load_dwordx4 v51, s[8:11], s27 offen offset:1024 sc1 lds
  buffer_load_dwordx4 v52, s[8:11], s27 offen offset:2048 sc1 lds
  s_add_u32 s27, s27, 98304
  s_add_u32 m0, s28, 12288
  s_nop 0
  buffer_load_dwordx4 v50, s[8:11], s27 offen offset:0 sc1 lds
  buffer_load_dwordx4 v51, s[8:11], s27 offen offset:1024 sc1 lds
  buffer_load_dwordx4 v52, s[8:11], s27 offen offset:2048 sc1 lds
  s_add_u32 s27, s27, 98304
  s_waitcnt vmcnt(6)
  s_mov_b32 s46, 0x8000
  s_branch KM_hc2
KM_hq2:
  s_sleep 2
  buffer_load_dwordx4 v[128:131], v53, s[12:15], s29 offen offset:256 sc1
  buffer_load_dwordx4 v[132:135], v54, s[12:15], s29 offen offset:1280 sc1
  buffer_load_dwordx4 v[136:139], v55, s[12:15], s29 offen offset:2304 sc1
  buffer_load_dwordx4 v[140:143], v56, s[12:15], s29 offen offset:3328 sc1
  s_waitcnt vmcnt(0)
KM_hc2:
  v_max3_u32 v12, v128, v129, v130
  v_max3_u32 v12, v12, v131, v132
  v_max3_u32 v12, v12, v133, v134
  v_max3_u32 v12, v12, v135, v136
  v_max3_u32 v12, v12, v137, v138
  v_max3_u32 v12, v12, v139, v140
  v_max3_u32 v12, v12, v141, v142
  v_max_u32 v12, v12, v143
  v_cmp_eq_u32 vcc, -1, v12
  s_nop 1
  s_and_b64 exec, exec, vcc
  s_cbranch_scc0 KM_ho2
  s_sub_u32 s46, s46, 1
  s_cmp_lg_u32 s46, 0
  s_cbranch_scc1 KM_hq2
KM_ho2:
  s_mov_b64 exec, -1
  ds_write_b128 v62, v[128:131] offset:32768
  ds_write_b128 v62, v[132:135] offset:33792
  ds_write_b128 v62, v[136:139] offset:34816
  ds_write_b128 v62, v[140:143] offset:35840
  s_mov_b32 s46, 0x8000
  s_branch KM_hc3
KM_hq3:
  s_sleep 2
  buffer_load_dwordx4 v[144:147], v53, s[12:15], s29 offen offset:384 sc1
  buffer_load_dwordx4 v[148:151], v54, s[12:15], s29 offen offset:1408 sc1
  buffer_load_dwordx4 v[152:155], v55, s[12:15], s29 offen offset:2432 sc1
  buffer_load_dwordx4 v[156:159], v56, s[12:15], s29 offen offset:3456 sc1
  s_waitcnt vmcnt(0)
KM_hc3:
  v_max3_u32 v12, v144, v145, v146
  v_max3_u32 v12, v12, v147, v148
  v_max3_u32 v12, v12, v149, v150
  v_max3_u32 v12, v12, v151, v152
  v_max3_u32 v12, v12, v153, v154
  v_max3_u32 v12, v12, v155, v156
  v_max3_u32 v12, v12, v157, v158
  v_max_u32 v12, v12, v159
  v_cmp_eq_u32 vcc, -1, v12
  s_nop 1
  s_and_b64 exec, exec, vcc
  s_cbranch_scc0 KM_ho3
  s_sub_u32 s46, s46, 1
  s_cmp_lg_u32 s46, 0
  s_cbranch_scc1 KM_hq3
KM_ho3:
  s_mov_b64 exec, -1
  ds_write_b128 v62, v[144:147] offset:49152
  ds_write_b128 v62, v[148:151] offset:50176
  ds_write_b128 v62, v[152:155] offset:51200
  ds_write_b128 v62, v[156:159] offset:52224
  s_waitcnt lgkmcnt(0)
  s_add_u32 s33, s29, 512
  s_barrier
  s_mov_b32 s46, 0x8000
KM_p1:
  buffer_load_dword v11, v57, s[12:15], s23 offen sc1
  s_waitcnt vmcnt(0)
  v_cmp_ne_u32 vcc, v11, v61
  s_nop 1
  s_and_b64 exec, exec, vcc
  s_cbranch_scc0 KM_p1_ok
  s_sleep 4
  s_sub_u32 s46, s46, 1
  s_cmp_lg_u32 s46, 0
  s_cbranch_scc1 KM_p1
KM_p1_ok:
  s_mov_b64 exec, -1
  s_add_u32 m0, s30, 98304
  s_nop 0
  buffer_load_dwordx4 v53, s[12:15], s33 offen offset:0 sc1 lds
  buffer_load_dwordx4 v54, s[12:15], s33 offen offset:1024 sc1 lds
  buffer_load_dwordx4 v55, s[12:15], s33 offen offset:2048 sc1 lds
  buffer_load_dwordx4 v56, s[12:15], s33 offen offset:3072 sc1 lds
  s_add_u32 s33, s33, 128
  s_add_u32 m0, s30, 114688
  s_nop 0
  buffer_load_dwordx4 v53, s[12:15], s33 offen offset:0 sc1 lds
  buffer_load_dwordx4 v54, s[12:15], s33 offen offset:1024 sc1 lds
  buffer_load_dwordx4 v55, s[12:15], s33 offen offset:2048 sc1 lds
  buffer_load_dwordx4 v56, s[12:15], s33 offen offset:3072 sc1 lds
  s_add_u32 s33, s33, 128
  s_add_u32 m0, s28, 24576
  s_nop 0
  buffer_load_dwordx4 v50, s[8:11], s27 offen offset:0 sc1 lds
  buffer_load_dwordx4 v51, s[8:11], s27 offen offset:1024 sc1 lds
  buffer_load_dwordx4 v52, s[8:11], s27 offen offset:2048 sc1 lds
  s_add_u32 s27, s27, 98304
  s_add_u32 m0, s28, 36864
  s_nop 0
  buffer_load_dwordx4 v50, s[8:11], s27 offen offset:0 sc1 lds
  buffer_load_dwordx4 v51, s[8:11], s27 offen offset:1024 sc1 lds
  buffer_load_dwordx4 v52, s[8:11], s27 offen offset:2048 sc1 lds
  s_add_u32 s27, s27, 98304
  s_barrier
  s_add_u32 m0, s30, 131072
  s_nop 0
  buffer_load_dwordx4 v53, s[12:15], s33 offen offset:0 sc1 lds
  buffer_load_dwordx4 v54, s[12:15], s33 offen offset:1024 sc1 lds
  buffer_load_dwordx4 v55, s[12:15], s33 offen offset:2048 sc1 lds
  buffer_load_dwordx4 v56, s[12:15], s33 offen offset:3072 sc1 lds
  s_add_u32 s33, s33, 128
  s_add_u32 m0, s28, 49152
  s_nop 0
  buffer_load_dwordx4 v50, s[8:11], s27 offen offset:0 sc1 lds
  buffer_load_dwordx4 v51, s[8:11], s27 offen offset:1024 sc1 lds
  buffer_load_dwordx4 v52, s[8:11], s27 offen offset:2048 sc1 lds
  s_add_u32 s27, s27, 98304
  s_add_u32 m0, s28, 61440
  s_nop 0
  buffer_load_dwordx4 v50, s[8:11], s27 offen offset:0 sc1 lds
  buffer_load_dwordx4 v51, s[8:11], s27 offen offset:1024 sc1 lds
  buffer_load_dwordx4 v52, s[8:11], s27 offen offset:2048 sc1 lds
  s_add_u32 s27, s27, 98304
  s_waitcnt vmcnt(20)
  s_barrier
  s_add_u32 m0, s30, 147456
  s_nop 0
  buffer_load_dwordx4 v53, s[12:15], s33 offen offset:0 sc1 lds
  buffer_load_dwordx4 v54, s[12:15], s33 offen offset:1024 sc1 lds
  buffer_load_dwordx4 v55, s[12:15], s33 offen offset:2048 sc1 lds
  buffer_load_dwordx4 v56, s[12:15], s33 offen offset:3072 sc1 lds
  s_add_u32 s33, s33, 128
  s_add_u32 m0, s28, 73728
  s_nop 0
  buffer_load_dwordx4 v50, s[8:11], s27 offen offset:0 sc1 lds
  buffer_load_dwordx4 v51, s[8:11], s27 offen offset:1024 sc1 lds
  buffer_load_dwordx4 v52, s[8:11], s27 offen offset:2048 sc1 lds
  s_add_u32 s27, s27, 98304
  s_add_u32 m0, s28, 86016
  s_nop 0
  buffer_load_dwordx4 v50, s[8:11], s27 offen offset:0 sc1 lds
  buffer_load_dwordx4 v51, s[8:11], s27 offen offset:1024 sc1 lds
  buffer_load_dwordx4 v52, s[8:11], s27 offen offset:2048 sc1 lds
  s_add_u32 s27, s27, 98304
  s_waitcnt vmcnt(20)
  s_barrier
  s_add_u32 m0, s30, 98304
  s_nop 0
  buffer_load_dwordx4 v53, s[12:15], s33 offen offset:0 sc1 lds
  buffer_load_dwordx4 v54, s[12:15], s33 offen offset:1024 sc1 lds
  buffer_load_dwordx4 v55, s[12:15], s33 offen offset:2048 sc1 lds
  buffer_load_dwordx4 v56, s[12:15], s33 offen offset:3072 sc1 lds
  s_add_u32 s33, s33, 128
  s_add_u32 m0, s28, 0
  s_nop 0
  buffer_load_dwordx4 v50, s[8:11], s27 offen offset:0 sc1 lds
  buffer_load_dwordx4 v51, s[8:11], s27 offen offset:1024 sc1 lds
  buffer_load_dwordx4 v52, s[8:11], s27 offen offset:2048 sc1 lds
  s_add_u32 s27, s27, 98304
  s_add_u32 m0, s28, 12288
  s_nop 0
  buffer_load_dwordx4 v50, s[8:11], s27 offen offset:0 sc1 lds
  buffer_load_dwordx4 v51, s[8:11], s27 offen offset:1024 sc1 lds
  buffer_load_dwordx4 v52, s[8:11], s27 offen offset:2048 sc1 lds
  s_add_u32 s27, s27, 98304
  s_waitcnt vmcnt(20)
  s_barrier
  s_add_u32 m0, s30, 114688
  s_nop 0
  buffer_load_dwordx4 v53, s[12:15], s33 offen offset:0 sc1 lds
  buffer_load_dwordx4 v54, s[12:15], s33 offen offset:1024 sc1 lds
  buffer_load_dwordx4 v55, s[12:15], s33 offen offset:2048 sc1 lds
  buffer_load_dwordx4 v56, s[12:15], s33 offen offset:3072 sc1 lds
  s_add_u32 s33, s33, 128
  s_add_u32 m0, s28, 24576
  s_nop 0
  buffer_load_dwordx4 v50, s[8:11], s27 offen offset:0 sc1 lds
  buffer_load_dwordx4 v51, s[8:11], s27 offen offset:1024 sc1 lds
  buffer_load_dwordx4 v52, s[8:11], s27 offen offset:2048 sc1 lds
  s_add_u32 s27, s27, 98304
  s_add_u32 m0, s28, 36864
  s_nop 0
  buffer_load_dwordx4 v50, s[8:11], s27 offen offset:0 sc1 lds
  buffer_load_dwordx4 v51, s[8:11], s27 offen offset:1024 sc1 lds
  buffer_load_dwordx4 v52, s[8:11], s27 offen offset:2048 sc1 lds
  s_add_u32 s27, s27, 98304
  s_waitcnt vmcnt(20)
  s_barrier
  s_add_u32 m0, s31, 51200
  s_nop 0
  buffer_load_dwordx4 v59, s[12:15], s32 offen sc1 lds
  buffer_load_dwordx4 v59, s[12:15], s32 offen offset:1024 sc1 lds
  s_mov_b32 exec_hi, 0
  buffer_load_dwordx4 v59, s[12:15], s32 offen offset:2048 sc1 lds
  s_mov_b32 exec_hi, -1
  s_add_u32 s32, s32, 10240
  s_add_u32 m0, s31, 61440
  s_nop 0
  buffer_load_dwordx4 v59, s[12:15], s32 offen sc1 lds
  buffer_load_dwordx4 v59, s[12:15], s32 offen offset:1024 sc1 lds
  s_mov_b32 exec_hi, 0
  buffer_load_dwordx4 v59, s[12:15], s32 offen offset:2048 sc1 lds
  s_mov_b32 exec_hi, -1
  s_add_u32 s32, s32, 10240
  s_add_u32 m0, s31, 133120
  s_nop 0
  buffer_load_dwordx4 v59, s[12:15], s32 offen sc1 lds
  buffer_load_dwordx4 v59, s[12:15], s32 offen offset:1024 sc1 lds
  s_mov_b32 exec_hi, 0
  buffer_load_dwordx4 v59, s[12:15], s32 offen offset:2048 sc1 lds
  s_mov_b32 exec_hi, -1
  s_add_u32 s32, s32, 10240
  s_waitcnt vmcnt(19)
  s_barrier
  s_add_u32 m0, s31, 71680
  s_nop 0
  buffer_load_dwordx4 v59, s[12:15], s32 offen sc1 lds
  buffer_load_dwordx4 v59, s[12:15], s32 offen offset:1024 sc1 lds
  s_mov_b32 exec_hi, 0
  buffer_load_dwordx4 v59, s[12:15], s32 offen offset:2048 sc1 lds
  s_mov_b32 exec_hi, -1
  s_add_u32 s32, s32, 10240
  s_add_u32 m0, s31, 81920
  s_nop 0
  buffer_load_dwordx4 v59, s[12:15], s32 offen sc1 lds
  buffer_load_dwordx4 v59, s[12:15], s32 offen offset:1024 sc1 lds
  s_mov_b32 exec_hi, 0
  buffer_load_dwordx4 v59, s[12:15], s32 offen offset:2048 sc1 lds
  s_mov_b32 exec_hi, -1
  s_add_u32 s32, s32, 10240
  s_add_u32 m0, s31, 143360
  s_nop 0
  buffer_load_dwordx4 v59, s[12:15], s32 offen sc1 lds
  buffer_load_dwordx4 v59, s[12:15], s32 offen offset:1024 sc1 lds
  s_mov_b32 exec_hi, 0
  buffer_load_dwordx4 v59, s[12:15], s32 offen offset:2048 sc1 lds
  s_mov_b32 exec_hi, -1
  s_add_u32 s32, s32, 10240
  s_add_u32 m0, s31, 153600
  s_nop 0
  buffer_load_dwordx4 v59, s[12:15], s32 offen sc1 lds
  buffer_load_dwordx4 v59, s[12:15], s32 offen offset:1024 sc1 lds
  s_mov_b32 exec_hi, 0
  buffer_load_dwordx4 v59, s[12:15], s32 offen offset:2048 sc1 lds
  s_mov_b32 exec_hi, -1
  s_add_u32 s32, s32, 10240
  s_waitcnt vmcnt(21)
  s_barrier
  s_add_u32 m0, s31, 0
  s_nop 0
  buffer_load_dwordx4 v59, s[12:15], s32 offen sc1 lds
  buffer_load_dwordx4 v59, s[12:15], s32 offen offset:1024 sc1 lds
  s_mov_b32 exec_hi, 0
  buffer_load_dwordx4 v59, s[12:15], s32 offen offset:2048 sc1 lds
  s_mov_b32 exec_hi, -1
  s_add_u32 s32, s32, 10240
  s_add_u32 m0, s31, 10240
  s_nop 0
  buffer_load_dwordx4 v59, s[12:15], s32 offen sc1 lds
  buffer_load_dwordx4 v59, s[12:15], s32 offen offset:1024 sc1 lds
  s_mov_b32 exec_hi, 0
  buffer_load_dwordx4 v59, s[12:15], s32 offen offset:2048 sc1 lds
  s_mov_b32 exec_hi, -1
  s_add_u32 s32, s32, 10240
  s_add_u32 m0, s31, 92160
  s_nop 0
  buffer_load_dwordx4 v59, s[12:15], s32 offen sc1 lds
  buffer_load_dwordx4 v59, s[12:15], s32 offen offset:1024 sc1 lds
  s_mov_b32 exec_hi, 0
  buffer_load_dwordx4 v59, s[12:15], s32 offen offset:2048 sc1 lds
  s_mov_b32 exec_hi, -1
  s_add_u32 s32, s32, 10240
  s_add_u32 m0, s31, 102400
  s_nop 0
  buffer_load_dwordx4 v59, s[12:15], s32 offen sc1 lds
  buffer_load_dwordx4 v59, s[12:15], s32 offen offset:1024 sc1 lds
  s_mov_b32 exec_hi, 0
  buffer_load_dwordx4 v59, s[12:15], s32 offen offset:2048 sc1 lds
  s_mov_b32 exec_hi, -1
  s_add_u32 s32, s32, 10240
  s_barrier
  s_add_u32 m0, s31, 20480
  s_nop 0
  buffer_load_dwordx4 v59, s[12:15], s32 offen sc1 lds
  buffer_load_dwordx4 v59, s[12:15], s32 offen offset:1024 sc1 lds
  s_mov_b32 exec_hi, 0
  buffer_load_dwordx4 v59, s[12:15], s32 offen offset:2048 sc1 lds
  s_mov_b32 exec_hi, -1
  s_add_u32 s32, s32, 10240
  s_add_u32 m0, s31, 30720
  s_nop 0
  buffer_load_dwordx4 v59, s[12:15], s32 offen sc1 lds
  buffer_load_dwordx4 v59, s[12:15], s32 offen offset:1024 sc1 lds
  s_mov_b32 exec_hi, 0
  buffer_load_dwordx4 v59, s[12:15], s32 offen offset:2048 sc1 lds
  s_mov_b32 exec_hi, -1
  s_add_u32 s32, s32, 10240
  s_add_u32 m0, s31, 40960
  s_nop 0
  buffer_load_dwordx4 v59, s[12:15], s32 offen sc1 lds
  buffer_load_dwordx4 v59, s[12:15], s32 offen offset:1024 sc1 lds
  s_mov_b32 exec_hi, 0
  buffer_load_dwordx4 v59, s[12:15], s32 offen offset:2048 sc1 lds
  s_mov_b32 exec_hi, -1
  s_add_u32 s32, s32, 10240
  s_add_u32 m0, s31, 112640
  s_nop 0
  buffer_load_dwordx4 v59, s[12:15], s32 offen sc1 lds
  buffer_load_dwordx4 v59, s[12:15], s32 offen offset:1024 sc1 lds
  s_mov_b32 exec_hi, 0
  buffer_load_dwordx4 v59, s[12:15], s32 offen offset:2048 sc1 lds
  s_mov_b32 exec_hi, -1
  s_add_u32 s32, s32, 10240
  s_add_u32 m0, s31, 122880
  s_nop 0
  buffer_load_dwordx4 v59, s[12:15], s32 offen sc1 lds
  buffer_load_dwordx4 v59, s[12:15], s32 offen offset:1024 sc1 lds
  s_mov_b32 exec_hi, 0
  buffer_load_dwordx4 v59, s[12:15], s32 offen offset:2048 sc1 lds
  s_mov_b32 exec_hi, -1
  s_add_u32 s32, s32, 10240
  s_waitcnt vmcnt(0)
  s_barrier
  s_waitcnt vmcnt(0)
  s_barrier
  s_add_u32 m0, s31, 51200
  s_nop 0
  buffer_load_dwordx4 v59, s[12:15], s32 offen sc1 lds
  buffer_load_dwordx4 v59, s[12:15], s32 offen offset:1024 sc1 lds
  s_mov_b32 exec_hi, 0
  buffer_load_dwordx4 v59, s[12:15], s32 offen offset:2048 sc1 lds
  s_mov_b32 exec_hi, -1
  s_add_u32 s32, s32, 10240
  s_add_u32 m0, s31, 61440
  s_nop 0
  buffer_load_dwordx4 v59, s[12:15], s32 offen sc1 lds
  buffer_load_dwordx4 v59, s[12:15], s32 offen offset:1024 sc1 lds
  s_mov_b32 exec_hi, 0
  buffer_load_dwordx4 v59, s[12:15], s32 offen offset:2048 sc1 lds
  s_mov_b32 exec_hi, -1
  s_add_u32 s32, s32, 10240
  s_add_u32 m0, s31, 133120
  s_nop 0
  buffer_load_dwordx4 v59, s[12:15], s32 offen sc1 lds
  buffer_load_dwordx4 v59, s[12:15], s32 offen offset:1024 sc1 lds
  s_mov_b32 exec_hi, 0
  buffer_load_dwordx4 v59, s[12:15], s32 offen offset:2048 sc1 lds
  s_mov_b32 exec_hi, -1
  s_add_u32 s32, s32, 10240
  s_add_u32 m0, s31, 71680
  s_nop 0
  buffer_load_dwordx4 v59, s[12:15], s32 offen sc1 lds
  buffer_load_dwordx4 v59, s[12:15], s32 offen offset:1024 sc1 lds
  s_mov_b32 exec_hi, 0
  buffer_load_dwordx4 v59, s[12:15], s32 offen offset:2048 sc1 lds
  s_mov_b32 exec_hi, -1
  s_add_u32 s32, s32, 10240
  s_waitcnt vmcnt(12)
  s_barrier
  s_add_u32 m0, s31, 81920
  s_nop 0
  buffer_load_dwordx4 v59, s[12:15], s32 offen sc1 lds
  buffer_load_dwordx4 v59, s[12:15], s32 offen offset:1024 sc1 lds
  s_mov_b32 exec_hi, 0
  buffer_load_dwordx4 v59, s[12:15], s32 offen offset:2048 sc1 lds
  s_mov_b32 exec_hi, -1
  s_add_u32 s32, s32, 10240
  s_add_u32 m0, s31, 143360
  s_nop 0
  buffer_load_dwordx4 v59, s[12:15], s32 offen sc1 lds
  buffer_load_dwordx4 v59, s[12:15], s32 offen offset:1024 sc1 lds
  s_mov_b32 exec_hi, 0
  buffer_load_dwordx4 v59, s[12:15], s32 offen offset:2048 sc1 lds
  s_mov_b32 exec_hi, -1
  s_add_u32 s32, s32, 10240
  s_add_u32 m0, s31, 153600
  s_nop 0
  buffer_load_dwordx4 v59, s[12:15], s32 offen sc1 lds
  buffer_load_dwordx4 v59, s[12:15], s32 offen offset:1024 sc1 lds
  s_mov_b32 exec_hi, 0
  buffer_load_dwordx4 v59, s[12:15], s32 offen offset:2048 sc1 lds
  s_mov_b32 exec_hi, -1
  s_add_u32 s32, s32, 10240
  s_add_u32 m0, s31, 0
  s_nop 0
  buffer_load_dwordx4 v59, s[12:15], s32 offen sc1 lds
  buffer_load_dwordx4 v59, s[12:15], s32 offen offset:1024 sc1 lds
  s_mov_b32 exec_hi, 0
  buffer_load_dwordx4 v59, s[12:15], s32 offen offset:2048 sc1 lds
  s_mov_b32 exec_hi, -1
  s_add_u32 s32, s32, 10240
  s_waitcnt vmcnt(12)
  s_barrier
  s_waitcnt vmcnt(0)
  s_barrier
KM_end:
  s_endpgm
.section .rodata,"a"
.p2align 6
.amdhsa_kernel adaLN_cond__spectral_gfnet__glu_gated_geglu__prompt_kernel
  .amdhsa_next_free_vgpr 168
  .amdhsa_next_free_sgpr 100
  .amdhsa_accum_offset 168
  .amdhsa_group_segment_fixed_size 0
  .amdhsa_kernarg_size 96
  .amdhsa_user_sgpr_count 2
  .amdhsa_user_sgpr_kernarg_segment_ptr 1
  .amdhsa_system_sgpr_workgroup_id_x 1
.end_amdhsa_kernel
```
